```python
import torch

def _softmax(x, axis=-1):
    return torch.softmax(x, dim=axis)
def _gelu(x):
    return torch.nn.functional.gelu(x, approximate="tanh")
def _silu(x):
    return torch.nn.functional.silu(x)
def _sigmoid(x):
    return torch.sigmoid(x)
def _layernorm(x, axis=-1, eps=1e-5):
    m = x.mean(dim=axis, keepdim=True)
    v = x.var(dim=axis, keepdim=True, unbiased=False)
    return (x - m) / torch.sqrt(v + eps)
def _scatter_add(tgt, idx, src, axis=0):
    return tgt.clone().index_add_(axis, idx, src)
def _segment_sum(src, seg, n):
    out = torch.zeros((n,) + src.shape[1:], dtype=src.dtype)
    return out.index_add_(0, seg, src)
def _pad(x, pw):
    flat = tuple(v for pair in reversed(pw) for v in pair)
    return torch.nn.functional.pad(x, flat)

kernel_name = 'interleave_layers__ssm_conv_s4__linear_attn_block__prompt'

def setup_inputs():

    _w = (lambda a: (lambda t: t.to(torch.bfloat16) if t.is_floating_point() else t)(torch.as_tensor(a)))
    def _A_setup():
        B, L, D, N = 1, 2048, 512, 128
        A_re = -(lambda _x: torch.exp(torch.as_tensor(_x)))((lambda *s: torch.randn(*s, dtype=torch.bfloat16) * 1.6)(D, N))
        A_im = torch.pi * (lambda *s: torch.randn(*s, dtype=torch.bfloat16) * 0.05)(D, N)
        B_re = (lambda *s: torch.randn(*s, dtype=torch.bfloat16) * 0.05)(D, N)
        B_im = (lambda *s: torch.randn(*s, dtype=torch.bfloat16) * 0.05)(D, N)
        C_re = (lambda *s: torch.randn(*s, dtype=torch.bfloat16) * 0.05)(D, N)
        C_im = (lambda *s: torch.randn(*s, dtype=torch.bfloat16) * 0.05)(D, N)
        log_dt = (lambda *s: torch.randn(*s, dtype=torch.bfloat16) * 0.05)(D) * 0.5 - 4.0
        Dskip = (lambda *s: torch.randn(*s, dtype=torch.bfloat16) * 0.05)(D)
        return {
            "u": _w((lambda *s: torch.randn(*s, dtype=torch.bfloat16) * 0.05)(B, L, D)),
            "A_re": _w(A_re),
            "A_im": _w(A_im),
            "B_re": _w(B_re),
            "B_im": _w(B_im),
            "C_re": _w(C_re),
            "C_im": _w(C_im),
            "log_dt": _w(log_dt),
            "Dskip": _w(Dskip),
        }
    _A_in = _A_setup()

    def _B_setup():
        B, S, D = 1, 2048, 512
        return {
            "x": _w((lambda *s: torch.randn(*s, dtype=torch.bfloat16) * 0.05)(B, S, D)),
            "wqkv": _w((lambda *s: torch.randn(*s, dtype=torch.bfloat16) * 0.1)(D, 3 * D)),
            "wo": _w((lambda *s: torch.randn(*s, dtype=torch.bfloat16) * 0.05)(D, D)),
        }
    _B_in = _B_setup()

    return {
        "A_u": _A_in["u"],
        "A_A_re": _A_in["A_re"],
        "A_A_im": _A_in["A_im"],
        "A_B_re": _A_in["B_re"],
        "A_B_im": _A_in["B_im"],
        "A_C_re": _A_in["C_re"],
        "A_C_im": _A_in["C_im"],
        "A_log_dt": _A_in["log_dt"],
        "A_Dskip": _A_in["Dskip"],
        "B_x": _B_in["x"],
        "B_wqkv": _B_in["wqkv"],
        "B_wo": _B_in["wo"],
    }

def reference(A_u, A_A_re, A_A_im, A_B_re, A_B_im, A_C_re, A_C_im, A_log_dt, A_Dskip, B_x, B_wqkv, B_wo):
    def _A_ref(u, A_re, A_im, B_re, B_im, C_re, C_im, log_dt, Dskip):
        Bsz, L, D = u.shape
        dt = torch.exp(log_dt)[:, None]
        A = A_re + 1j * A_im
        Bc = B_re + 1j * B_im
        Cc = C_re + 1j * C_im
        logdA = dt * A
        dB = dt * Bc
        l = (lambda x, dt: x.to(dt))(torch.arange(L), A_re.dtype)
        P = torch.exp(logdA[:, :, None] * l[None, None, :])
        K = torch.einsum("dn,dnl,dn->dl", Cc, P, dB).real
        L2 = 2 * L
        Kp = _pad(K, ((0, 0), (0, L)))
        up = (lambda x, *d: x.permute(*d))(u, 0, 2, 1)
        up = _pad(up, ((0, 0), (0, 0), (0, L)))
        Kf = (lambda x, axes=(-2,-1): torch.fft.rfft2(x.float(), dim=axes))(Kp[:, None, :], axes=(-2, -1))
        Uf = (lambda x, axes=(-2,-1): torch.fft.rfft2(x.float(), dim=axes))(up[:, :, None, :], axes=(-2, -1))
        Yf = Uf * Kf[None, :, :, :]
        y = (lambda x, s, axes=(-2,-1): torch.fft.irfft2(x, s=s, dim=axes).to(torch.bfloat16))(Yf, (1, L2), axes=(-2, -1))[:, :, 0, :L]
        y = (lambda x, *d: x.permute(*d))(y, 0, 2, 1) + u * Dskip[None, None, :]
        return y

    def _B_ref(x, wqkv, wo):
        B, S, D = x.shape
        H = 32; Dh = D // H
        qkv = (lambda x, *d: x.permute(*d))((x @ wqkv).reshape(B, S, 3, H, Dh), 2, 0, 3, 1, 4)
        q, k, v = qkv[0], qkv[1], qkv[2]
        phi = lambda t: torch.where(t > 0, t + 1, torch.exp(t)) + 1e-6
        pq, pk = phi(q), phi(k)
        kv = torch.einsum("bhsd,bhse->bhde", pk, v)
        z = torch.einsum("bhsd->bhd", pk)
        num = torch.einsum("bhqd,bhde->bhqe", pq, kv)
        den = torch.einsum("bhqd,bhd->bhq", pq, z)[..., None] + 1e-6
        o = num / den
        return (lambda x, *d: x.permute(*d))(o, 0, 2, 1, 3).reshape(B, S, D) @ wo

    x = A_u
    x = x + _A_ref(_layernorm(x, axis=-1), A_A_re, A_A_im, A_B_re, A_B_im, A_C_re, A_C_im, A_log_dt, A_Dskip)
    x = x + _B_ref(_layernorm(x, axis=-1), B_wqkv, B_wo)
    x = x + _A_ref(_layernorm(x, axis=-1), A_A_re, A_A_im, A_B_re, A_B_im, A_C_re, A_C_im, A_log_dt, A_Dskip)
    x = x + _B_ref(_layernorm(x, axis=-1), B_wqkv, B_wo)
    return x
```

```asm
; @launch grid=(256,1,1) block=(256,1,1) lds=163584
.amdgcn_target "amdgcn-amd-amdhsa--gfx950"
.text
.globl interleave_layers__ssm_conv_s4__linear_attn_block__prompt_kernel
.p2align 12
.p2align 8
.type interleave_layers__ssm_conv_s4__linear_attn_block__prompt_kernel,@function
interleave_layers__ssm_conv_s4__linear_attn_block__prompt_kernel:
    s_cmp_ge_u32 s2, 256
    s_cbranch_scc1 L_end
    s_load_dwordx16 s[4:19], s[0:1], 0
    s_load_dwordx8 s[20:27], s[0:1], 64
    s_load_dwordx4 s[28:31], s[0:1], 96
    s_load_dwordx2 s[32:33], s[0:1], 112
    s_getpc_b64 s[68:69]
L_pc:
    s_lshr_b32 s54, s2, 3
    v_lshrrev_b32 v50, 4, v0
    v_lshl_add_u32 v50, v50, 5, s54
    v_lshlrev_b32_e64 v50, 7, v50
    v_min_u32 v50, L_end-L_pc, v50
    global_load_dword v50, v50, s[68:69]
    v_lshrrev_b32 v51, 6, v0
    v_and_b32 v1, 63, v0
    v_readfirstlane_b32 s48, v51
    s_and_b32 s53, s2, 7
    s_and_b32 s55, s54, 3
    s_lshl_b32 s49, s53, 2
    s_add_u32 s49, s49, s55
    s_lshr_b32 s50, s54, 2
    s_lshr_b32 s51, s50, 1
    s_and_b32 s52, s50, 1
    v_lshlrev_b32 v2, 4, v1
    v_and_b32 v54, 15, v1
    v_lshrrev_b32 v55, 4, v1
    v_lshrrev_b32 v56, 5, v1
    s_and_b32 s68, s54, 7
    s_lshl_b32 s68, s68, 7
    v_lshl_add_u32 v32, v1, 10, s68
    s_lshl_b32 s68, s54, 10
    v_lshl_add_u32 v33, v1, 7, s68
    s_lshl_b32 s53, s49, 6
    s_lshl2_add_u32 s54, s52, s51
    s_lshl3_add_u32 s54, s54, s53
    s_lshl_b32 s68, s48, 1
    s_add_u32 s55, s54, s68
    s_lshl_b32 s54, s55, 10
    v_add_u32 v59, s54, v2
    v_and_b32_e64 v60, 1, v55
    v_add_lshl_u32 v60, v60, s55, 2
    v_lshl_add_u32 v60, v56, 13, v60
    s_lshl_b32 s54, s52, 5
    s_add_u32 s53, s53, s54
    v_and_b32 v57, 31, v1
    v_add_u32 v57, s53, v57
    s_lshl_b32 s53, s51, 8
    s_lshl_b32 s54, s48, 6
    s_add_u32 s53, s53, s54
    v_lshl_add_u32 v7, v57, 10, s53
    v_lshl_add_u32 v7, v56, 5, v7
    s_lshl_b32 s53, s53, 11
    v_lshl_add_u32 v8, v57, 2, s53
    v_lshl_add_u32 v8, v56, 16, v8
    v_readfirstlane_b32 s53, v7
    v_lshrrev_b32 v57, 2, v1
    v_xor_b32 v58, v1, v55
    v_and_b32 v58, 3, v58
    v_lshl_add_u32 v61, v57, 10, s53
    v_lshl_add_u32 v61, v58, 4, v61
    v_add_u32 v62, 15360, v61
    s_mul_i32 s3, s48, 4160
    s_add_u32 s3, s3, 131072
    s_mov_b32 m0, s3
    s_lshl_b32 s54, s2, 9
    v_lshl_add_u32 v63, v0, 1, s54
    s_lshl_b32 s55, s2, 2
    s_add_u32 s61, s55, s48
    v_lshrrev_b32_e64 v57, 3, v1
    v_mul_u32_u24 v36, 3072, v57
    v_bfe_u32 v57, v1, 1, 2
    v_xor_b32_e64 v57, v57, v55
    v_lshl_add_u32 v36, v57, 5, v36
    v_and_b32_e64 v57, 1, v1
    v_lshl_add_u32 v36, v57, 4, v36
    v_lshl_add_u32 v36, s50, 7, v36
    v_mov_b32 v64, 0
    v_mov_b32 v65, 0
    v_mov_b32 v66, 0
    v_mov_b32 v67, 0
    s_mov_b32 s38, 0xf00000
    s_mov_b32 s39, 0x20000
    s_mov_b32 s42, 0x180000
    s_mov_b32 s43, 0x20000
    s_lshr_b32 s53, s61, 1
    s_mul_i32 s53, s53, 3072
    s_and_b32 s54, s48, 1
    s_lshl_b32 s54, s54, 9
    s_add_u32 s53, s53, s54
    v_lshl_add_u32 v90, v1, 7, s53
    s_cmp_eq_u32 s48, 0
    s_cselect_b32 s54, 1, 0x100
    v_lshlrev_b32_e64 v91, 7, s54
    s_waitcnt lgkmcnt(0)
    s_and_b32 s53, s61, 0x3e3
    s_cbranch_scc1 L_noinit
    v_lshl_add_u32 v57, s2, 12, v2
    global_store_dwordx4 v57, v[64:67], s[32:33] offset:0 sc1
    global_store_dwordx4 v57, v[64:67], s[32:33] offset:1024 sc1
    global_store_dwordx4 v57, v[64:67], s[32:33] offset:2048 sc1
    global_store_dwordx4 v57, v[64:67], s[32:33] offset:3072 sc1
L_noinit:
    s_mov_b64 exec, 1
    global_load_dword v51, v59, s[4:5]
    s_cmp_eq_u32 s48, 0
    s_cselect_b64 s[68:69], s[30:31], s[32:33]
    global_load_dword v53, v91, s[68:69]
    s_mov_b64 exec, -1
    s_nop 0
    global_load_ushort v84, v63, s[6:7]
    global_load_ushort v85, v63, s[8:9]
    global_load_ushort v86, v63, s[10:11]
    global_load_ushort v87, v63, s[12:13]
    global_load_ushort v88, v63, s[14:15]
    global_load_ushort v89, v63, s[16:17]
    s_mov_b64 exec, 15
    global_load_dword v52, v90, s[24:25] offset:1024
    s_mov_b64 exec, -1
    s_load_dword s56, s[18:19], s55
    s_load_dword s57, s[20:21], s55
    s_barrier
    global_load_dwordx4 v[68:71], v59, s[4:5] offset:0
    global_load_dwordx4 v[72:75], v59, s[4:5] offset:1024
    global_load_lds_dwordx4 v61, s[4:5] offset:0
    global_load_lds_dwordx4 v62, s[4:5] offset:1024
    s_mov_b64 s[36:37], s[32:33]
    s_mov_b64 s[40:41], s[24:25]
    s_and_b32 s67, s61, 0x3e3
    s_cbranch_scc1 L_noflag
    v_mov_b32 v34, 1
    s_mov_b64 exec, 1
    s_waitcnt vmcnt(13)
    global_atomic_add v64, v34, s[30:31]
    s_mov_b64 exec, -1
L_noflag:
    s_lshr_b32 s53, s48, 1
    s_and_b32 s54, s48, 1
    s_mul_i32 s68, s48, 15552
    s_add_u32 s68, s68, 65536
    v_lshl_add_u32 v59, v1, 2, s68
    s_mul_i32 s68, s53, 31104
    s_add_u32 s68, s68, 65536
    v_lshl_add_u32 v58, v55, 4, s68
    v_mul_u32_u24 v61, 288, v54
    v_add_u32_e64 v61, v61, v58
    s_mul_i32 s69, s54, 4608
    v_add_u32 v92, s69, v61
    v_min_u32 v63, 4, v54
    v_mul_u32_u24 v63, 288, v63
    v_add_u32_e64 v63, v63, v58
    s_mul_i32 s68, s53, 4608
    s_add_u32 s68, s68, 148224
    s_lshl_b32 s69, s54, 2
    v_and_b32 v57, 3, v54
    v_lshl_add_u32 v97, v57, 3, s69
    v_lshrrev_b32 v57, 2, v54
    v_add_u32 v97, v97, v57
    v_lshl_add_u32 v95, v55, 7, v97
    v_lshl_add_u32 v95, v95, 2, s68
    v_max_u32 v58, 1, v55
    v_sub_u32 v58, 6, v58
    v_lshlrev_b32 v93, v58, v97
    v_lshrrev_b32 v98, 1, v97
    v_lshl_add_u32 v93, v98, 3, v93
    s_mov_b32 s69, 0x70480100
    v_lshlrev_b32_e64 v58, 3, v55
    v_bfe_u32 v58, s69, v58, 8
    v_lshl_add_u32 v58, v58, 4, s68
    v_add_u32 v93, v93, v58
    v_cmp_eq_u32 vcc, 3, v55
    v_mov_b32 v97, 384
    s_nop 0
    v_cndmask_b32 v58, 8, v97, vcc
    v_add_u32_e64 v94, v93, v58
    v_and_b32 v57, 127, v0
    v_sub_u32 v97, 127, v57
    v_or_b32 v58, 8, v97
    v_ffbh_u32 v58, v58
    v_sub_u32 v98, 28, v58
    v_lshlrev_b32 v98, 3, v98
    s_mov_b32 s69, 0x2060a12
    v_bfe_u32 v58, s69, v98, 8
    v_mul_u32_u24_e64 v58, v58, v97
    s_mov_b32 s69, 0x80402000
    v_bfe_u32 v117, s69, v98, 8
    v_lshl_add_u32 v58, v117, 2, v58
    v_cmp_lt_u32 vcc, 64, v97
    v_lshlrev_b32 v117, 4, v57
    v_sub_u32 v117, 753, v117
    v_cndmask_b32_e64 v58, v58, -16, vcc
    v_cmp_gt_u32 vcc, 8, v57
    s_nop 1
    v_cndmask_b32_e64 v58, v58, v117, vcc
    v_cndmask_b32_e64 v98, v98, 0, vcc
    v_lshl_add_u32 v115, v58, 2, s68
    s_mov_b32 s69, 0xfc18283c
    v_bfe_i32 v58, s69, v98, 8
    v_add_u32_e64 v100, v58, v115
    s_mov_b32 s69, 0xfc181c38
    v_bfe_i32 v58, s69, v98, 8
    v_add_u32_e64 v101, v58, v115
    s_mov_b32 s69, 0xfc0c1834
    v_bfe_i32 v58, s69, v98, 8
    v_add_u32_e64 v102, v58, v115
    s_mov_b32 s69, 0xfc0c1830
    v_bfe_i32 v58, s69, v98, 8
    v_add_u32_e64 v103, v58, v115
    s_mov_b32 s69, 0xfc0c182c
    v_bfe_i32 v58, s69, v98, 8
    v_add_u32_e64 v104, v58, v115
    s_mov_b32 s69, 0xfc081428
    v_bfe_i32 v58, s69, v98, 8
    v_add_u32_e64 v105, v58, v115
    s_mov_b32 s69, 0xfc081024
    v_bfe_i32 v58, s69, v98, 8
    v_add_u32_e64 v106, v58, v115
    s_mov_b32 s69, 0xfc081020
    v_bfe_i32 v58, s69, v98, 8
    v_add_u32_e64 v107, v58, v115
    s_mov_b32 s69, 0xfc08101c
    v_bfe_i32 v58, s69, v98, 8
    v_add_u32_e64 v108, v58, v115
    s_mov_b32 s69, 0xfc080c18
    v_bfe_i32 v58, s69, v98, 8
    v_add_u32_e64 v109, v58, v115
    s_mov_b32 s69, 0xfc040814
    v_bfe_i32 v58, s69, v98, 8
    v_add_u32_e64 v110, v58, v115
    s_mov_b32 s69, 0x40810
    v_bfe_i32 v58, s69, v98, 8
    v_add_u32_e64 v111, v58, v115
    s_mov_b32 s69, 0x4080c
    v_bfe_i32 v58, s69, v98, 8
    v_add_u32_e64 v112, v58, v115
    s_mov_b32 s69, 0x408
    v_bfe_i32 v58, s69, v98, 8
    v_add_u32 v113, v58, v115
    s_mov_b32 s69, 0x4
    v_bfe_i32 v58, s69, v98, 8
    v_add_u32 v114, v58, v115
    v_cmp_ge_u32 vcc, 16, v97
    s_nop 1
    v_cndmask_b32 v58, 0, 12, vcc
    v_sub_u32 v116, v115, v58
    s_mul_i32 s69, s53, 8320
    s_add_u32 s69, s69, 131072
    v_lshl_add_u32 v96, v57, 5, s69
    v_lshl_add_u32 v58, v57, 2, s68
    v_subrev_u32 v58, 512, v58
    ds_write_b32 v58, v64
    v_mov_b32_e64 v58, s68
    ds_write_b32 v58, v64 offset:2556
    s_mul_i32 s68, s48, 4160
    s_add_u32 s68, s68, 135168
    v_lshl_add_u32 v58, v54, 2, s68
    ds_write_b32 v58, v64
    s_lshl_b32 s53, s61, 7
    s_add_u32 s53, s53, 0x10000
    s_mov_b64 exec, 0xff
    buffer_store_dwordx4 v[64:67], v2, s[36:39], s53 offen sc1
    s_mov_b64 exec, -1
    v_and_b32_e64 v57, 31, v1
    v_lshl_add_u32 v62, v57, 6, s3
    v_bfe_u32 v57, v1, 2, 2
    v_lshlrev_b32 v58, 1, v56
    v_xor_b32 v57, v57, v58
    v_lshl_add_u32 v62, v57, 4, v62
    v_lshl_add_u32 v10, s48, 11, v2
    v_lshrrev_b32_e64 v11, 1, v10
    v_add_u32 v11, 148224, v11
    s_lshr_b32 s53, s48, 1
    s_and_b32 s54, s48, 1
    s_mul_i32 s68, s53, 4608
    s_lshl_b32 s69, s54, 8
    s_sub_u32 s68, s68, s69
    s_add_u32 s68, s68, 148000
    v_lshl_add_u32 v16, v54, 5, s68
    v_lshl_add_u32 v16, v55, 4, v16
    s_mul_i32 s68, s53, 8320
    s_sub_u32 s68, s68, s69
    s_add_u32 s68, s68, 138588
    v_and_b32 v57, 1, v54
    v_mul_u32_u24 v57, 4160, v57
    v_lshrrev_b32_e64 v58, 1, v54
    v_lshl_add_u32 v57, v58, 2, v57
    v_lshl_add_u32 v58, v55, 4, s68
    v_sub_u32_e64 v12, v58, v57
    v_subrev_u32 v13, 1024, v12
    v_subrev_u32 v14, 2048, v12
    s_mul_i32 s68, s53, 8320
    s_lshl_b32 s69, s54, 6
    s_add_u32 s68, s68, s69
    s_add_u32 s68, s68, 131132
    v_lshl_add_u32 v15, v55, 4, s68
    v_lshlrev_b32 v57, 2, v54
    v_sub_u32 v15, v15, v57
    s_mul_i32 s68, s54, 4112
    s_sub_u32 s68, 8176, s68
    v_lshlrev_b32_e64 v57, v54, s68
    v_lshlrev_b32 v58, 3, v55
    v_lshrrev_b32 v57, v58, v57
    v_bfe_u32 v58, v57, 0, 2
    v_lshl_or_b32 v58, v58, 15, v58
    v_and_b32 v58, 0x10001, v58
    v_mul_u32_u24 v118, 0x3f80, v58
    v_bfe_u32 v58, v57, 2, 2
    v_lshl_or_b32 v58, v58, 15, v58
    v_and_b32 v58, 0x10001, v58
    v_mul_u32_u24 v119, 0x3f80, v58
    v_bfe_u32 v58, v57, 4, 2
    v_lshl_or_b32 v58, v58, 15, v58
    v_and_b32 v58, 0x10001, v58
    v_mul_u32_u24 v120, 0x3f80, v58
    v_bfe_u32 v58, v57, 6, 2
    v_lshl_or_b32 v58, v58, 15, v58
    v_and_b32 v58, 0x10001, v58
    v_mul_u32_u24 v121, 0x3f80, v58
    v_lshl_add_u32 v57, s54, 10, v2
    v_add_u32 v57, 157440, v57
    ds_write_b128 v57, v[118:121]
    s_mul_i32 s68, s48, 10240
    s_add_u32 s68, s68, 65536
    v_lshl_add_u32 v17, v55, 6, s68
    v_add_u32_e64 v17, v17, v2
    s_mul_i32 s68, s48, 2560
    s_add_u32 s68, s68, 65536
    v_and_b32_e64 v57, 3, v1
    v_mul_u32_u24 v18, 316, v57
    v_lshl_add_u32 v18, v1, 2, v18
    v_add_u32 v18, s68, v18
    s_lshl_b32 s68, s48, 19
    s_lshl_b32 s69, s2, 8
    s_add_u32 s68, s68, s69
    v_lshl_add_u32 v19, v55, 16, s68
    v_lshl_add_u32 v19, v54, 3, v19
    s_and_b32 s69, s2, 3
    s_lshl_b32 s69, s69, 5
    v_xor_b32 v19, s69, v19
    v_lshrrev_b32 v57, 2, v1
    v_lshlrev_b32_e64 v3, 7, v57
    v_bfe_u32 v57, v1, 3, 2
    v_xor_b32_e64 v57, s48, v57
    v_lshl_add_u32 v3, v57, 5, v3
    v_and_b32_e64 v57, 3, v1
    v_lshl_add_u32 v3, v57, 3, v3
    s_mov_b32 s62, 0x3b000000
    s_mov_b32 s63, 0x3727c5ac
    s_mov_b32 s60, 0x3f803f80
    s_mov_b32 s64, 0x3fb8aa3b
    v_mov_b32 v46, s60
    v_mov_b32 v47, s60
    v_mov_b32 v48, s60
    v_mov_b32 v49, s60
    v_xor_b32 v58, 16, v62
    s_branch L_pg1
.p2align 12
L_pg1:
    v_and_b32 v97, 15, v1
    v_lshrrev_b32 v98, 4, v1
    v_lshrrev_b32_e64 v99, 5, v1
    s_mov_b32 s22, 0xaaaaaaaa
    s_mov_b32 s34, 0xcccccccc
    s_mov_b32 s23, 0xaaaaaaaa
    s_mov_b32 s35, 0xcccccccc
    s_mov_b32 s66, 0x358637bd
    s_lshl_b32 s8, s51, 13
    s_add_u32 s8, s8, 0x34000
    s_movk_i32 s9, 0x3f00
    s_mov_b32 s65, 0xb5c1a2a0
    v_xor_b32 v4, 32, v3
    v_xor_b32 v5, 64, v3
    v_xor_b32 v6, 96, v3
    s_lshl_b32 s53, s49, 16
    s_lshl_b32 s54, s48, 12
    s_add_u32 s53, s53, s54
    v_add_u32 v20, s53, v2
    s_lshl_b32 s54, s50, 2
    s_add_u32 s54, s54, s48
    s_lshl_b32 s54, s54, 10
    s_lshl_b32 s53, s49, 16
    s_add_u32 s53, s53, s54
    v_lshl_add_u32 v21, v97, 5, s53
    v_lshl_add_u32 v21, v98, 3, v21
    s_lshr_b32 s53, s48, 1
    v_lshl_add_u32 v21, s53, 15, v21
    s_and_b32 s53, s48, 1
    v_lshl_add_u32 v21, s53, 9, v21
    s_mul_i32 s53, s53, 512
    s_sub_u32 s53, s54, s53
    v_lshl_add_u32 v22, v98, 4, s53
    v_and_b32_e64 v118, 3, v97
    v_lshl_add_u32 v22, v118, 2, v22
    v_bfe_u32 v118, v97, 2, 1
    v_lshl_add_u32 v22, v118, 10, v22
    v_lshrrev_b32_e64 v118, 3, v97
    v_lshl_add_u32 v22, v118, 6, v22
    s_lshr_b32 s53, s54, 2
    v_lshl_add_u32 v23, v1, 2, s53
    s_lshl_b32 s53, s48, 6
    s_add_u32 s53, s53, 156928
    v_lshl_add_u32 v30, v97, 2, s53
    v_lshl_add_u32 v31, v98, 4, s53
    s_lshl_b32 s0, s48, 17
    s_lshl_b32 s53, s51, 2
    s_add_u32 s53, s53, s48
    v_lshl_add_u32 v39, s53, 10, v2
    s_lshl_b32 s53, s50, 2
    s_add_u32 s53, s53, s48
    v_lshl_add_u32 v38, s53, 10, v2
    s_mov_b32 s17, s61
    v_and_b32 v57, 1, v1
    s_lshl_b32 s1, s17, 10
    s_add_u32 s1, s1, 0xe00000
    s_lshl_b32 s46, s48, 10
    s_add_u32 s46, s46, 159488
    s_cmp_ge_u32 s2, 128
    s_cselect_b64 s[44:45], s[26:27], s[24:25]
    s_cbranch_scc1 L_wo_src
    s_lshr_b32 s53, s2, 3
    s_mul_i32 s53, s53, 98304
    s_and_b32 s54, s17, 31
    s_lshl_b32 s54, s54, 5
    s_add_u32 s53, s53, s54
    v_lshl_add_u32 v97, v57, 4, s53
    v_lshrrev_b32 v57, 1, v1
    v_mul_u32_u24 v57, 3072, v57
    v_add_u32_e64 v97, v97, v57
    v_lshl_add_u32 v98, v1, 3, s46
    s_branch L_w_src
L_wo_src:
    s_bfe_u32 s53, s2, 0x50002
    s_lshl_b32 s53, s53, 14
    s_and_b32 s54, s17, 15
    s_lshl_b32 s54, s54, 6
    s_add_u32 s53, s53, s54
    s_nop 0
    v_lshl_add_u32 v98, v57, 5, s46
    v_lshl_add_u32 v97, v56, 11, s53
    v_bfe_u32 v57, v1, 3, 2
    v_lshl_add_u32 v97, v57, 12, v97
    v_bfe_u32 v57, v1, 2, 1
    v_lshl_add_u32 v97, v57, 10, v97
    v_and_b32_e64 v57, 3, v1
    v_lshl_add_u32 v97, v57, 4, v97
    v_lshrrev_b32_e64 v57, 2, v54
    v_lshl_add_u32 v98, v57, 7, v98
    v_lshl_add_u32 v98, v56, 6, v98
    v_and_b32_e64 v57, 1, v55
    v_lshl_add_u32 v98, v57, 4, v98
    v_bfe_u32 v57, v1, 1, 1
    v_lshl_add_u32 v98, v57, 3, v98
L_w_src:
    s_mul_i32 s16, s48, 16384
    s_add_u32 m0, s16, 0
    s_nop 0
    s_mul_i32 s3, s48, 393216
    s_add_u32 s3, s3, 1024
    buffer_load_dwordx4 v36, s[40:43], s3 offen offset:0 lds
    s_add_u32 s3, s3, 23552
    buffer_load_dwordx4 v36, s[40:43], s3 offen offset:1024 lds
    s_add_u32 s3, s3, 23552
    buffer_load_dwordx4 v36, s[40:43], s3 offen offset:2048 lds
    s_add_u32 s3, s3, 23552
    buffer_load_dwordx4 v36, s[40:43], s3 offen offset:3072 lds
    s_waitcnt vmcnt(8)
    v_dot2_f32_bf16 v118, v68, s60, 0
    v_dot2_f32_bf16 v120, v68, v68, 0
    s_waitcnt vmcnt(7)
    v_dot2_f32_bf16 v119, v72, s60, 0
    v_dot2_f32_bf16 v121, v72, v72, 0
    v_dot2_f32_bf16 v118, v69, s60, v118
    v_dot2_f32_bf16 v120, v69, v69, v120
    v_dot2_f32_bf16 v119, v73, s60, v119
    v_dot2_f32_bf16 v121, v73, v73, v121
    v_dot2_f32_bf16 v118, v70, s60, v118
    v_dot2_f32_bf16 v120, v70, v70, v120
    v_dot2_f32_bf16 v119, v74, s60, v119
    v_dot2_f32_bf16 v121, v74, v74, v121
    v_dot2_f32_bf16 v118, v71, s60, v118
    v_dot2_f32_bf16 v120, v71, v71, v120
    v_dot2_f32_bf16 v119, v75, s60, v119
    v_dot2_f32_bf16 v121, v75, v75, v121
    s_waitcnt vmcnt(5)
    ds_read_b128 v[76:79], v62
    ds_read_b128 v[80:83], v58
    s_mov_b32 s53, 0x30000
    v_permlane32_swap_b32 v118, v120
    v_permlane32_swap_b32 v119, v121
    v_add_f32 v118, v118, v120
    v_add_f32 v119, v119, v121
    s_nop 1
    v_permlane16_swap_b32 v118, v119
    v_add_f32 v118, v118, v119
    s_nop 1
    v_add_f32_dpp v118, v118, v118 row_ror:8 row_mask:0xf bank_mask:0xf
    s_nop 1
    v_add_f32_dpp v118, v118, v118 row_ror:4 row_mask:0xf bank_mask:0xf
    s_nop 1
    v_add_f32_dpp v118, v118, v118 row_ror:2 row_mask:0xf bank_mask:0xf
    s_nop 1
    v_add_f32_dpp v118, v118, v118 row_ror:1 row_mask:0xf bank_mask:0xf
    s_mov_b32 exec_lo, 0x00010001
    s_mov_b32 exec_hi, 0x00010001
    buffer_atomic_swap v118, v60, s[36:39], s53 offen
    s_mov_b64 exec, -1
    s_mov_b32 s53, 0x200000
    s_waitcnt lgkmcnt(1)
    buffer_store_dword v76, v8, s[36:39], s53 offen sc1
    s_add_u32 s53, s53, 8192
    buffer_store_dword v77, v8, s[36:39], s53 offen sc1
    s_add_u32 s53, s53, 8192
    buffer_store_dword v78, v8, s[36:39], s53 offen sc1
    s_add_u32 s53, s53, 8192
    buffer_store_dword v79, v8, s[36:39], s53 offen sc1
    s_add_u32 s53, s53, 8192
    s_waitcnt lgkmcnt(0)
    s_nop 0
    buffer_store_dword v80, v8, s[36:39], s53 offen sc1
    s_add_u32 s53, s53, 8192
    buffer_store_dword v81, v8, s[36:39], s53 offen sc1
    s_add_u32 s53, s53, 8192
    buffer_store_dword v82, v8, s[36:39], s53 offen sc1
    s_add_u32 s53, s53, 8192
    buffer_store_dword v83, v8, s[36:39], s53 offen sc1
    s_waitcnt lgkmcnt(0)
    s_lshl_b32 s53, s56, 16
    s_and_b32 s54, s56, 0xffff0000
    s_lshl_b32 s56, s57, 16
    s_and_b32 s57, s57, 0xffff0000
    s_cmp_ge_u32 s48, 2
    s_cselect_b32 s53, s54, s53
    v_mov_b32 v90, s53
    v_mul_f32 v90, s64, v90
    v_exp_f32 v90, v90
    v_lshlrev_b32 v84, 16, v84
    v_lshlrev_b32 v85, 16, v85
    v_lshlrev_b32 v86, 16, v86
    v_lshlrev_b32 v87, 16, v87
    v_lshlrev_b32 v88, 16, v88
    v_lshlrev_b32 v89, 16, v89
    v_cvt_pk_bf16_f32 v90, v90, v90
    v_and_b32 v90, 0xffff0000, v90
    v_pk_mul_f32 v[84:85], v[84:85], v[90:91] op_sel:[0,0] op_sel_hi:[1,0]
    v_pk_mul_f32 v[86:87], v[86:87], v[90:91] op_sel:[0,0] op_sel_hi:[1,0]
    v_pk_mul_f32 v[124:125], v[88:89], v[86:87] op_sel:[0,0] op_sel_hi:[0,1]
    v_pk_fma_f32 v[126:127], v[88:89], v[86:87], v[124:125] op_sel:[1,1,0] op_sel_hi:[1,0,1] neg_lo:[1,0,0]
    v_mul_f32 v124, 0x3fb8aa3b, v84
    v_mul_f32 v125, 0x3e22f983, v85
    v_exp_f32 v124, v124
    v_fract_f32 v125, v125
    v_cos_f32 v128, v125
    v_sin_f32 v129, v125
    s_nop 0
    v_pk_mul_f32 v[128:129], v[128:129], v[124:125] op_sel:[0,0] op_sel_hi:[1,0]
    v_mul_f32 v124, 0x4138aa3b, v84
    v_mul_f32 v125, 0x3fa2f983, v85
    v_exp_f32 v124, v124
    v_fract_f32 v125, v125
    v_cos_f32 v130, v125
    v_sin_f32 v131, v125
    s_nop 0
    v_pk_mul_f32 v[130:131], v[130:131], v[124:125] op_sel:[0,0] op_sel_hi:[1,0]
    v_mul_f32 v124, 0x42b8aa3b, v84
    v_mul_f32 v125, 0x4122f983, v85
    v_exp_f32 v124, v124
    v_fract_f32 v125, v125
    v_cos_f32 v132, v125
    v_sin_f32 v133, v125
    s_nop 0
    v_pk_mul_f32 v[132:133], v[132:133], v[124:125] op_sel:[0,0] op_sel_hi:[1,0]
    v_mul_f32 v124, 0x43b8aa3b, v84
    v_mul_f32 v125, 0x4222f983, v85
    v_exp_f32 v124, v124
    v_fract_f32 v125, v125
    v_cos_f32 v134, v125
    v_sin_f32 v135, v125
    s_nop 0
    s_nop 0
    v_pk_mul_f32 v[134:135], v[134:135], v[124:125] op_sel:[0,0] op_sel_hi:[1,0]
    v_pk_mul_f32 v[124:125], v[132:133], v[132:133] op_sel:[0,0] op_sel_hi:[0,1]
    v_pk_fma_f32 v[138:139], v[132:133], v[132:133], v[124:125] op_sel:[1,1,0] op_sel_hi:[1,0,1] neg_lo:[1,0,0]
    v_pk_mul_f32 v[124:125], v[138:139], v[132:133] op_sel:[0,0] op_sel_hi:[0,1]
    v_pk_fma_f32 v[140:141], v[138:139], v[132:133], v[124:125] op_sel:[1,1,0] op_sel_hi:[1,0,1] neg_lo:[1,0,0]
    v_pk_mul_f32 v[124:125], v[128:129], v[128:129] op_sel:[0,0] op_sel_hi:[0,1]
    v_pk_fma_f32 v[142:143], v[128:129], v[128:129], v[124:125] op_sel:[1,1,0] op_sel_hi:[1,0,1] neg_lo:[1,0,0]
    v_pk_mul_f32 v[124:125], v[142:143], v[142:143] op_sel:[0,0] op_sel_hi:[0,1]
    v_pk_fma_f32 v[144:145], v[142:143], v[142:143], v[124:125] op_sel:[1,1,0] op_sel_hi:[1,0,1] neg_lo:[1,0,0]
    v_mov_b32 v99, 0x3f80
    v_cvt_pk_bf16_f32 v136, v132, v133
    ds_write2_b32 v59, v99, v136 offset0:0 offset1:72
    s_add_u32 m0, s16, 4096
    s_add_u32 s3, s3, 27648
    buffer_load_dwordx4 v36, s[40:43], s3 offen offset:0 lds
    v_cvt_pk_bf16_f32 v99, v138, v139
    v_cvt_pk_bf16_f32 v136, v140, v141
    ds_write2_b32 v59, v99, v136 offset0:144 offset1:216
    v_add_u32 v59, 1152, v59
    s_cmp_lg_u32 s48, 0
    s_cbranch_scc1 L_noflagld
    global_load_dword v53, v64, s[30:31] sc1
L_noflagld:
    v_cvt_pk_bf16_f32 v99, v130, v131
    v_pk_mul_f32 v[124:125], v[130:131], v[132:133] op_sel:[0,0] op_sel_hi:[0,1]
    v_pk_fma_f32 v[148:149], v[130:131], v[132:133], v[124:125] op_sel:[1,1,0] op_sel_hi:[1,0,1] neg_lo:[1,0,0]
    v_cvt_pk_bf16_f32 v136, v148, v149
    ds_write2_b32 v59, v99, v136 offset0:0 offset1:72
    s_add_u32 s3, s3, 23552
    buffer_load_dwordx4 v36, s[40:43], s3 offen offset:1024 lds
    v_pk_mul_f32 v[124:125], v[130:131], v[138:139] op_sel:[0,0] op_sel_hi:[0,1]
    v_pk_fma_f32 v[148:149], v[130:131], v[138:139], v[124:125] op_sel:[1,1,0] op_sel_hi:[1,0,1] neg_lo:[1,0,0]
    v_cvt_pk_bf16_f32 v99, v148, v149
    v_pk_mul_f32 v[124:125], v[130:131], v[140:141] op_sel:[0,0] op_sel_hi:[0,1]
    v_pk_fma_f32 v[148:149], v[130:131], v[140:141], v[124:125] op_sel:[1,1,0] op_sel_hi:[1,0,1] neg_lo:[1,0,0]
    v_cvt_pk_bf16_f32 v136, v148, v149
    ds_write2_b32 v59, v99, v136 offset0:144 offset1:216
    v_add_u32 v59, 1152, v59
    v_pk_mul_f32 v[124:125], v[130:131], v[130:131] op_sel:[0,0] op_sel_hi:[0,1]
    v_pk_fma_f32 v[146:147], v[130:131], v[130:131], v[124:125] op_sel:[1,1,0] op_sel_hi:[1,0,1] neg_lo:[1,0,0]
    v_cvt_pk_bf16_f32 v99, v146, v147
    v_pk_mul_f32 v[124:125], v[146:147], v[132:133] op_sel:[0,0] op_sel_hi:[0,1]
    v_pk_fma_f32 v[148:149], v[146:147], v[132:133], v[124:125] op_sel:[1,1,0] op_sel_hi:[1,0,1] neg_lo:[1,0,0]
    v_cvt_pk_bf16_f32 v136, v148, v149
    ds_write2_b32 v59, v99, v136 offset0:0 offset1:72
    s_add_u32 s3, s3, 23552
    buffer_load_dwordx4 v36, s[40:43], s3 offen offset:2048 lds
    v_pk_mul_f32 v[124:125], v[146:147], v[138:139] op_sel:[0,0] op_sel_hi:[0,1]
    v_pk_fma_f32 v[148:149], v[146:147], v[138:139], v[124:125] op_sel:[1,1,0] op_sel_hi:[1,0,1] neg_lo:[1,0,0]
    v_cvt_pk_bf16_f32 v99, v148, v149
    v_pk_mul_f32 v[124:125], v[146:147], v[140:141] op_sel:[0,0] op_sel_hi:[0,1]
    v_pk_fma_f32 v[148:149], v[146:147], v[140:141], v[124:125] op_sel:[1,1,0] op_sel_hi:[1,0,1] neg_lo:[1,0,0]
    v_cvt_pk_bf16_f32 v136, v148, v149
    ds_write2_b32 v59, v99, v136 offset0:144 offset1:216
    v_add_u32 v59, 1152, v59
    v_pk_mul_f32 v[124:125], v[146:147], v[130:131] op_sel:[0,0] op_sel_hi:[0,1]
    v_pk_fma_f32 v[146:147], v[146:147], v[130:131], v[124:125] op_sel:[1,1,0] op_sel_hi:[1,0,1] neg_lo:[1,0,0]
    v_cvt_pk_bf16_f32 v99, v146, v147
    v_pk_mul_f32 v[124:125], v[146:147], v[132:133] op_sel:[0,0] op_sel_hi:[0,1]
    v_pk_fma_f32 v[148:149], v[146:147], v[132:133], v[124:125] op_sel:[1,1,0] op_sel_hi:[1,0,1] neg_lo:[1,0,0]
    v_cvt_pk_bf16_f32 v136, v148, v149
    ds_write2_b32 v59, v99, v136 offset0:0 offset1:72
    s_add_u32 s3, s3, 23552
    buffer_load_dwordx4 v36, s[40:43], s3 offen offset:3072 lds
    v_pk_mul_f32 v[124:125], v[146:147], v[138:139] op_sel:[0,0] op_sel_hi:[0,1]
    v_pk_fma_f32 v[148:149], v[146:147], v[138:139], v[124:125] op_sel:[1,1,0] op_sel_hi:[1,0,1] neg_lo:[1,0,0]
    v_cvt_pk_bf16_f32 v99, v148, v149
    v_pk_mul_f32 v[124:125], v[146:147], v[140:141] op_sel:[0,0] op_sel_hi:[0,1]
    v_pk_fma_f32 v[148:149], v[146:147], v[140:141], v[124:125] op_sel:[1,1,0] op_sel_hi:[1,0,1] neg_lo:[1,0,0]
    v_cvt_pk_bf16_f32 v136, v148, v149
    ds_write2_b32 v59, v99, v136 offset0:144 offset1:216
    v_add_u32 v59, 1152, v59
    v_pk_mul_f32 v[124:125], v[146:147], v[130:131] op_sel:[0,0] op_sel_hi:[0,1]
    v_pk_fma_f32 v[146:147], v[146:147], v[130:131], v[124:125] op_sel:[1,1,0] op_sel_hi:[1,0,1] neg_lo:[1,0,0]
    v_cvt_pk_bf16_f32 v99, v146, v147
    v_pk_mul_f32 v[124:125], v[146:147], v[132:133] op_sel:[0,0] op_sel_hi:[0,1]
    v_pk_fma_f32 v[148:149], v[146:147], v[132:133], v[124:125] op_sel:[1,1,0] op_sel_hi:[1,0,1] neg_lo:[1,0,0]
    v_cvt_pk_bf16_f32 v136, v148, v149
    ds_write2_b32 v59, v99, v136 offset0:0 offset1:72
    v_pk_mul_f32 v[124:125], v[146:147], v[138:139] op_sel:[0,0] op_sel_hi:[0,1]
    v_pk_fma_f32 v[148:149], v[146:147], v[138:139], v[124:125] op_sel:[1,1,0] op_sel_hi:[1,0,1] neg_lo:[1,0,0]
    v_cvt_pk_bf16_f32 v99, v148, v149
    s_add_u32 m0, s16, 8192
    s_add_u32 s3, s3, 27648
    buffer_load_dwordx4 v36, s[40:43], s3 offen offset:0 lds
    v_pk_mul_f32 v[124:125], v[146:147], v[140:141] op_sel:[0,0] op_sel_hi:[0,1]
    v_pk_fma_f32 v[148:149], v[146:147], v[140:141], v[124:125] op_sel:[1,1,0] op_sel_hi:[1,0,1] neg_lo:[1,0,0]
    v_cvt_pk_bf16_f32 v136, v148, v149
    ds_write2_b32 v59, v99, v136 offset0:144 offset1:216
    v_add_u32 v59, 1152, v59
    v_pk_mul_f32 v[124:125], v[146:147], v[130:131] op_sel:[0,0] op_sel_hi:[0,1]
    v_pk_fma_f32 v[146:147], v[146:147], v[130:131], v[124:125] op_sel:[1,1,0] op_sel_hi:[1,0,1] neg_lo:[1,0,0]
    v_cvt_pk_bf16_f32 v99, v146, v147
    v_pk_mul_f32 v[124:125], v[146:147], v[132:133] op_sel:[0,0] op_sel_hi:[0,1]
    v_pk_fma_f32 v[148:149], v[146:147], v[132:133], v[124:125] op_sel:[1,1,0] op_sel_hi:[1,0,1] neg_lo:[1,0,0]
    v_cvt_pk_bf16_f32 v136, v148, v149
    ds_write2_b32 v59, v99, v136 offset0:0 offset1:72
    v_pk_mul_f32 v[124:125], v[146:147], v[138:139] op_sel:[0,0] op_sel_hi:[0,1]
    v_pk_fma_f32 v[148:149], v[146:147], v[138:139], v[124:125] op_sel:[1,1,0] op_sel_hi:[1,0,1] neg_lo:[1,0,0]
    v_cvt_pk_bf16_f32 v99, v148, v149
    s_add_u32 s3, s3, 23552
    buffer_load_dwordx4 v36, s[40:43], s3 offen offset:1024 lds
    v_pk_mul_f32 v[124:125], v[146:147], v[140:141] op_sel:[0,0] op_sel_hi:[0,1]
    v_pk_fma_f32 v[148:149], v[146:147], v[140:141], v[124:125] op_sel:[1,1,0] op_sel_hi:[1,0,1] neg_lo:[1,0,0]
    v_cvt_pk_bf16_f32 v136, v148, v149
    ds_write2_b32 v59, v99, v136 offset0:144 offset1:216
    v_add_u32 v59, 1152, v59
    v_pk_mul_f32 v[124:125], v[146:147], v[130:131] op_sel:[0,0] op_sel_hi:[0,1]
    v_pk_fma_f32 v[146:147], v[146:147], v[130:131], v[124:125] op_sel:[1,1,0] op_sel_hi:[1,0,1] neg_lo:[1,0,0]
    v_cvt_pk_bf16_f32 v99, v146, v147
    v_pk_mul_f32 v[124:125], v[146:147], v[132:133] op_sel:[0,0] op_sel_hi:[0,1]
    v_pk_fma_f32 v[148:149], v[146:147], v[132:133], v[124:125] op_sel:[1,1,0] op_sel_hi:[1,0,1] neg_lo:[1,0,0]
    v_cvt_pk_bf16_f32 v136, v148, v149
    ds_write2_b32 v59, v99, v136 offset0:0 offset1:72
    v_pk_mul_f32 v[124:125], v[146:147], v[138:139] op_sel:[0,0] op_sel_hi:[0,1]
    v_pk_fma_f32 v[148:149], v[146:147], v[138:139], v[124:125] op_sel:[1,1,0] op_sel_hi:[1,0,1] neg_lo:[1,0,0]
    v_cvt_pk_bf16_f32 v99, v148, v149
    s_add_u32 s3, s3, 23552
    buffer_load_dwordx4 v36, s[40:43], s3 offen offset:2048 lds
    v_pk_mul_f32 v[124:125], v[146:147], v[140:141] op_sel:[0,0] op_sel_hi:[0,1]
    v_pk_fma_f32 v[148:149], v[146:147], v[140:141], v[124:125] op_sel:[1,1,0] op_sel_hi:[1,0,1] neg_lo:[1,0,0]
    v_cvt_pk_bf16_f32 v136, v148, v149
    ds_write2_b32 v59, v99, v136 offset0:144 offset1:216
    v_add_u32 v59, 1152, v59
    s_waitcnt vmcnt(7)
    s_barrier
    s_cmp_lg_u32 s48, 0
    s_cbranch_scc1 L_arr0
    s_mov_b32 s61, 0x200000
    s_waitcnt vmcnt(6)
L_arr0_init:
    v_readfirstlane_b32 s53, v53
    s_sub_u32 s61, s61, 1
    s_cbranch_scc1 L_arr0_go
    s_cmp_ge_u32 s53, 8
    s_cbranch_scc1 L_arr0_go
    global_load_dword v53, v64, s[30:31] sc1
    s_waitcnt vmcnt(0)
    s_branch L_arr0_init
L_arr0_go:
    v_mov_b32 v137, 1
    s_mov_b32 exec_hi, 0
    buffer_atomic_add v137, v32, s[36:39], 0 offen
    s_mov_b64 exec, -1
L_arr0:
    s_cmp_lg_u32 s48, 1
    s_cbranch_scc1 L_nowpf
    s_mul_i32 s53, s2, 6144
    v_lshrrev_b32 v137, 3, v1
    v_lshlrev_b32_e64 v137, 11, v137
    v_lshl_add_u32 v137, v1, 7, v137
    s_mov_b64 exec, 0xffff
    buffer_load_dword v34, v137, s[40:43], s53 offen offset:2048
    s_mov_b64 exec, -1
L_nowpf:
    s_nop 0
    v_pk_mul_f32 v[124:125], v[146:147], v[130:131] op_sel:[0,0] op_sel_hi:[0,1]
    v_pk_fma_f32 v[146:147], v[146:147], v[130:131], v[124:125] op_sel:[1,1,0] op_sel_hi:[1,0,1] neg_lo:[1,0,0]
    v_cvt_pk_bf16_f32 v99, v146, v147
    v_pk_mul_f32 v[124:125], v[146:147], v[132:133] op_sel:[0,0] op_sel_hi:[0,1]
    v_pk_fma_f32 v[148:149], v[146:147], v[132:133], v[124:125] op_sel:[1,1,0] op_sel_hi:[1,0,1] neg_lo:[1,0,0]
    v_cvt_pk_bf16_f32 v136, v148, v149
    ds_write2_b32 v59, v99, v136 offset0:0 offset1:72
    v_pk_mul_f32 v[124:125], v[146:147], v[138:139] op_sel:[0,0] op_sel_hi:[0,1]
    v_pk_fma_f32 v[148:149], v[146:147], v[138:139], v[124:125] op_sel:[1,1,0] op_sel_hi:[1,0,1] neg_lo:[1,0,0]
    v_cvt_pk_bf16_f32 v99, v148, v149
    s_add_u32 s3, s3, 23552
    buffer_load_dwordx4 v36, s[40:43], s3 offen offset:3072 lds
    v_pk_mul_f32 v[124:125], v[146:147], v[140:141] op_sel:[0,0] op_sel_hi:[0,1]
    v_pk_fma_f32 v[148:149], v[146:147], v[140:141], v[124:125] op_sel:[1,1,0] op_sel_hi:[1,0,1] neg_lo:[1,0,0]
    v_cvt_pk_bf16_f32 v136, v148, v149
    ds_write2_b32 v59, v99, v136 offset0:144 offset1:216
    v_add_u32 v59, 1152, v59
    v_cvt_pk_bf16_f32 v99, v126, -v127
    v_pk_mul_f32 v[124:125], v[126:127], v[128:129] op_sel:[0,0] op_sel_hi:[0,1]
    v_pk_fma_f32 v[146:147], v[126:127], v[128:129], v[124:125] op_sel:[1,1,0] op_sel_hi:[1,0,1] neg_lo:[1,0,0]
    v_cvt_pk_bf16_f32 v136, v146, -v147
    ds_write2_b32 v59, v99, v136 offset0:0 offset1:72
    v_pk_mul_f32 v[124:125], v[146:147], v[128:129] op_sel:[0,0] op_sel_hi:[0,1]
    v_pk_fma_f32 v[146:147], v[146:147], v[128:129], v[124:125] op_sel:[1,1,0] op_sel_hi:[1,0,1] neg_lo:[1,0,0]
    v_cvt_pk_bf16_f32 v99, v146, -v147
    v_pk_mul_f32 v[124:125], v[146:147], v[128:129] op_sel:[0,0] op_sel_hi:[0,1]
    v_pk_fma_f32 v[146:147], v[146:147], v[128:129], v[124:125] op_sel:[1,1,0] op_sel_hi:[1,0,1] neg_lo:[1,0,0]
    v_cvt_pk_bf16_f32 v136, v146, -v147
    ds_write2_b32 v59, v99, v136 offset0:144 offset1:216
    v_add_u32 v59, 1152, v59
    s_add_u32 m0, s16, 12288
    s_add_u32 s3, s3, 27648
    buffer_load_dwordx4 v36, s[40:43], s3 offen offset:0 lds
    v_pk_mul_f32 v[124:125], v[146:147], v[128:129] op_sel:[0,0] op_sel_hi:[0,1]
    v_pk_fma_f32 v[146:147], v[146:147], v[128:129], v[124:125] op_sel:[1,1,0] op_sel_hi:[1,0,1] neg_lo:[1,0,0]
    v_cvt_pk_bf16_f32 v99, v146, -v147
    v_pk_mul_f32 v[124:125], v[146:147], v[128:129] op_sel:[0,0] op_sel_hi:[0,1]
    v_pk_fma_f32 v[146:147], v[146:147], v[128:129], v[124:125] op_sel:[1,1,0] op_sel_hi:[1,0,1] neg_lo:[1,0,0]
    v_cvt_pk_bf16_f32 v136, v146, -v147
    ds_write2_b32 v59, v99, v136 offset0:0 offset1:72
    v_pk_mul_f32 v[124:125], v[146:147], v[128:129] op_sel:[0,0] op_sel_hi:[0,1]
    v_pk_fma_f32 v[146:147], v[146:147], v[128:129], v[124:125] op_sel:[1,1,0] op_sel_hi:[1,0,1] neg_lo:[1,0,0]
    v_cvt_pk_bf16_f32 v99, v146, -v147
    v_pk_mul_f32 v[124:125], v[146:147], v[128:129] op_sel:[0,0] op_sel_hi:[0,1]
    v_pk_fma_f32 v[146:147], v[146:147], v[128:129], v[124:125] op_sel:[1,1,0] op_sel_hi:[1,0,1] neg_lo:[1,0,0]
    v_cvt_pk_bf16_f32 v136, v146, -v147
    ds_write2_b32 v59, v99, v136 offset0:144 offset1:216
    v_add_u32 v59, 1152, v59
    s_add_u32 s3, s3, 23552
    buffer_load_dwordx4 v36, s[40:43], s3 offen offset:1024 lds
    v_pk_mul_f32 v[124:125], v[126:127], v[134:135] op_sel:[0,0] op_sel_hi:[0,1]
    v_pk_fma_f32 v[126:127], v[126:127], v[134:135], v[124:125] op_sel:[1,1,0] op_sel_hi:[1,0,1] neg_lo:[1,0,0]
    v_cvt_pk_bf16_f32 v99, v126, -v127
    v_pk_mul_f32 v[124:125], v[126:127], v[142:143] op_sel:[0,0] op_sel_hi:[0,1]
    v_pk_fma_f32 v[146:147], v[126:127], v[142:143], v[124:125] op_sel:[1,1,0] op_sel_hi:[1,0,1] neg_lo:[1,0,0]
    v_cvt_pk_bf16_f32 v136, v146, -v147
    ds_write2_b32 v59, v99, v136 offset0:0 offset1:72
    v_pk_mul_f32 v[124:125], v[146:147], v[142:143] op_sel:[0,0] op_sel_hi:[0,1]
    v_pk_fma_f32 v[146:147], v[146:147], v[142:143], v[124:125] op_sel:[1,1,0] op_sel_hi:[1,0,1] neg_lo:[1,0,0]
    v_cvt_pk_bf16_f32 v99, v146, -v147
    v_pk_mul_f32 v[124:125], v[146:147], v[142:143] op_sel:[0,0] op_sel_hi:[0,1]
    v_pk_fma_f32 v[146:147], v[146:147], v[142:143], v[124:125] op_sel:[1,1,0] op_sel_hi:[1,0,1] neg_lo:[1,0,0]
    v_cvt_pk_bf16_f32 v136, v146, -v147
    ds_write2_b32 v59, v99, v136 offset0:144 offset1:216
    v_add_u32 v59, 1152, v59
    s_add_u32 s3, s3, 23552
    buffer_load_dwordx4 v36, s[40:43], s3 offen offset:2048 lds
    v_pk_mul_f32 v[124:125], v[126:127], v[134:135] op_sel:[0,0] op_sel_hi:[0,1]
    v_pk_fma_f32 v[126:127], v[126:127], v[134:135], v[124:125] op_sel:[1,1,0] op_sel_hi:[1,0,1] neg_lo:[1,0,0]
    v_cvt_pk_bf16_f32 v99, v126, -v127
    v_pk_mul_f32 v[124:125], v[126:127], v[144:145] op_sel:[0,0] op_sel_hi:[0,1]
    v_pk_fma_f32 v[146:147], v[126:127], v[144:145], v[124:125] op_sel:[1,1,0] op_sel_hi:[1,0,1] neg_lo:[1,0,0]
    v_cvt_pk_bf16_f32 v136, v146, -v147
    ds_write2_b32 v59, v99, v136 offset0:0 offset1:72
    v_pk_mul_f32 v[124:125], v[126:127], v[134:135] op_sel:[0,0] op_sel_hi:[0,1]
    v_pk_fma_f32 v[126:127], v[126:127], v[134:135], v[124:125] op_sel:[1,1,0] op_sel_hi:[1,0,1] neg_lo:[1,0,0]
    v_cvt_pk_bf16_f32 v99, v126, -v127
    v_pk_mul_f32 v[124:125], v[126:127], v[144:145] op_sel:[0,0] op_sel_hi:[0,1]
    v_pk_fma_f32 v[146:147], v[126:127], v[144:145], v[124:125] op_sel:[1,1,0] op_sel_hi:[1,0,1] neg_lo:[1,0,0]
    v_cvt_pk_bf16_f32 v136, v146, -v147
    ds_write2_b32 v59, v99, v136 offset0:144 offset1:216
    v_add_u32 v59, 1152, v59
    s_add_u32 s3, s3, 23552
    buffer_load_dwordx4 v36, s[40:43], s3 offen offset:3072 lds
    v_pk_mul_f32 v[124:125], v[126:127], v[134:135] op_sel:[0,0] op_sel_hi:[0,1]
    v_pk_fma_f32 v[126:127], v[126:127], v[134:135], v[124:125] op_sel:[1,1,0] op_sel_hi:[1,0,1] neg_lo:[1,0,0]
    v_cvt_pk_bf16_f32 v99, v126, -v127
    v_pk_mul_f32 v[124:125], v[126:127], v[134:135] op_sel:[0,0] op_sel_hi:[0,1]
    v_pk_fma_f32 v[126:127], v[126:127], v[134:135], v[124:125] op_sel:[1,1,0] op_sel_hi:[1,0,1] neg_lo:[1,0,0]
    v_cvt_pk_bf16_f32 v136, v126, -v127
    ds_write2_b32 v59, v99, v136 offset0:0 offset1:72
    v_pk_mul_f32 v[124:125], v[126:127], v[134:135] op_sel:[0,0] op_sel_hi:[0,1]
    v_pk_fma_f32 v[126:127], v[126:127], v[134:135], v[124:125] op_sel:[1,1,0] op_sel_hi:[1,0,1] neg_lo:[1,0,0]
    v_cvt_pk_bf16_f32 v99, v126, -v127
    v_pk_mul_f32 v[124:125], v[126:127], v[134:135] op_sel:[0,0] op_sel_hi:[0,1]
    v_pk_fma_f32 v[126:127], v[126:127], v[134:135], v[124:125] op_sel:[1,1,0] op_sel_hi:[1,0,1] neg_lo:[1,0,0]
    v_cvt_pk_bf16_f32 v136, v126, -v127
    ds_write2_b32 v59, v99, v136 offset0:144 offset1:216
    v_add_u32 v59, 1152, v59
    v_pk_mul_f32 v[124:125], v[126:127], v[134:135] op_sel:[0,0] op_sel_hi:[0,1]
    v_pk_fma_f32 v[126:127], v[126:127], v[134:135], v[124:125] op_sel:[1,1,0] op_sel_hi:[1,0,1] neg_lo:[1,0,0]
    v_cvt_pk_bf16_f32 v99, v126, -v127
    ds_write_b32 v59, v99
    s_cmp_lg_u32 s48, 0
    s_cbranch_scc1 L_ps1
    s_mov_b64 exec, 0xff
    v_mov_b32_e64 v34, 0
    buffer_atomic_add v34, v33, s[36:39], 0 offen sc0
    s_mov_b64 exec, -1
L_ps1:
    s_waitcnt lgkmcnt(0)
    s_barrier
    ds_read_b128 v[68:71], v61 offset:9216
    ds_read_b128 v[72:75], v92 offset:0
    ds_read_b128 v[76:79], v63 offset:13824
    ds_read_b128 v[80:83], v61 offset:9280
    ds_read_b128 v[84:87], v92 offset:64
    ds_read_b128 v[88:91], v63 offset:13888
    ds_read_b128 v[118:121], v61 offset:9344
    ds_read_b128 v[122:125], v92 offset:128
    ds_read_b128 v[126:129], v63 offset:13952
    ds_read_b128 v[130:133], v61 offset:9408
    ds_read_b128 v[134:137], v92 offset:192
    ds_read_b128 v[138:141], v63 offset:14016
    ds_read_b128 v[142:145], v61 offset:24768
    ds_read_b128 v[146:149], v92 offset:15552
    ds_read_b128 v[150:153], v63 offset:29376
    s_waitcnt lgkmcnt(13)
    v_mfma_f32_16x16x32_bf16 v[50:53], v[68:71], v[72:75], 0
    ds_read_b128 v[68:71], v61 offset:24832
    s_waitcnt lgkmcnt(13)
    v_mfma_f32_16x16x32_bf16 v[64:67], v[76:79], v[72:75], 0
    ds_read_b128 v[76:79], v92 offset:15616
    s_waitcnt lgkmcnt(12)
    ds_read_b128 v[72:75], v63 offset:29440
    v_mfma_f32_16x16x32_bf16 v[50:53], v[80:83], v[84:87], v[50:53]
    ds_read_b128 v[80:83], v61 offset:24896
    s_waitcnt lgkmcnt(13)
    v_mfma_f32_16x16x32_bf16 v[64:67], v[88:91], v[84:87], v[64:67]
    ds_read_b128 v[88:91], v92 offset:15680
    s_waitcnt lgkmcnt(12)
    ds_read_b128 v[84:87], v63 offset:29504
    v_mfma_f32_16x16x32_bf16 v[50:53], v[118:121], v[122:125], v[50:53]
    ds_read_b128 v[118:121], v61 offset:24960
    s_waitcnt lgkmcnt(13)
    v_mfma_f32_16x16x32_bf16 v[64:67], v[126:129], v[122:125], v[64:67]
    ds_read_b128 v[126:129], v92 offset:15744
    s_waitcnt lgkmcnt(12)
    ds_read_b128 v[122:125], v63 offset:29568
    v_mfma_f32_16x16x32_bf16 v[50:53], v[130:133], v[134:137], v[50:53]
    s_waitcnt lgkmcnt(12)
    v_mfma_f32_16x16x32_bf16 v[64:67], v[138:141], v[134:137], v[64:67]
    s_waitcnt lgkmcnt(10)
    v_mfma_f32_16x16x32_bf16 v[50:53], v[142:145], v[146:149], v[50:53]
    s_waitcnt lgkmcnt(9)
    v_mfma_f32_16x16x32_bf16 v[64:67], v[150:153], v[146:149], v[64:67]
    s_waitcnt lgkmcnt(7)
    v_mfma_f32_16x16x32_bf16 v[50:53], v[68:71], v[76:79], v[50:53]
    s_waitcnt lgkmcnt(6)
    v_mfma_f32_16x16x32_bf16 v[64:67], v[72:75], v[76:79], v[64:67]
    s_waitcnt lgkmcnt(4)
    v_mfma_f32_16x16x32_bf16 v[50:53], v[80:83], v[88:91], v[50:53]
    s_waitcnt lgkmcnt(3)
    v_mfma_f32_16x16x32_bf16 v[64:67], v[84:87], v[88:91], v[64:67]
    s_waitcnt lgkmcnt(1)
    v_mfma_f32_16x16x32_bf16 v[50:53], v[118:121], v[126:129], v[50:53]
    s_waitcnt lgkmcnt(0)
    v_mfma_f32_16x16x32_bf16 v[64:67], v[122:125], v[126:129], v[64:67]
    s_nop 5
    ds_write_b64 v93, v[50:51]
    ds_write_b64 v94, v[52:53]
    v_add_u32 v95, 2560, v95
    s_mov_b32 exec_hi, 0
    ds_write2_b32 v95, v64, v65 offset0:0 offset1:32
    ds_write2_b32 v95, v66, v67 offset0:64 offset1:96
    s_mov_b64 exec, -1
    s_lshl_b32 s4, s48, 12
    s_mul_i32 s5, s48, 3072
    s_lshl_b32 s68, s2, 13
    s_add_u32 s68, s68, 0x200000
    s_mov_b32 s54, 0x30000
    s_mov_b32 s55, 0x32000
    s_branch L_pg2
.p2align 12
L_pg2:
    s_cmp_lg_u32 s48, 0
    s_cbranch_scc0 L_wait1_w0
    s_mov_b64 exec, 0
    s_branch L_stub_s1_0
L_tback_s1:
    s_mov_b64 exec, -1
    s_nop 0
    s_branch L_wait1
L_wait1_w0:
    s_mov_b64 exec, 0xff
    s_movk_i32 s53, 32
    s_mov_b32 s61, 0x100000
L_wait1_poll:
    v_mov_b32_e64 v35, 0
    buffer_atomic_add v35, v33, s[36:39], 0 offen sc0
    s_waitcnt vmcnt(1)
    v_cmp_gt_u32 vcc, s53, v34
    s_cbranch_vccz L_wait1_done
    v_mov_b32 v34, 0
    buffer_atomic_add v34, v33, s[36:39], 0 offen sc0
    s_sub_u32 s61, s61, 1
    s_cbranch_scc1 L_wait1_done
    s_waitcnt vmcnt(1)
    v_cmp_gt_u32 vcc, s53, v35
    s_cbranch_vccnz L_wait1_poll
L_wait1_done:
    s_mov_b64 exec, -1
L_wait1:
    s_waitcnt lgkmcnt(0)
    s_barrier
    buffer_load_dwordx4 v[64:67], v10, s[36:39], s54 offen offset:0 sc1
    buffer_load_dwordx4 v[72:75], v10, s[36:39], s55 offen offset:0 sc1
    buffer_load_dwordx4 v[50:53], v10, s[36:39], s68 offen offset:0 sc1
    s_barrier
    buffer_load_dwordx4 v[68:71], v10, s[36:39], s54 offen offset:1024 sc1
    buffer_load_dwordx4 v[76:79], v10, s[36:39], s55 offen offset:1024 sc1
    buffer_load_dwordx4 v[54:57], v10, s[36:39], s68 offen offset:1024 sc1
    v_mov_b32 v80, -1
    v_mov_b32 v81, -1
    v_mov_b32 v82, -1
    v_mov_b32 v83, -1
    s_mov_b32 m0, s46
    s_nop 0
    s_nop 0
    global_load_lds_dwordx4 v97, s[44:45]
    ds_read_b32 v100, v100
    ds_read_b32 v101, v101
    ds_read_b32 v102, v102
    ds_read_b32 v103, v103
    ds_read_b32 v104, v104
    ds_read_b32 v105, v105
    ds_read_b32 v106, v106
    ds_read_b32 v107, v107
    ds_read_b32 v108, v108
    ds_read_b32 v109, v109
    ds_read_b32 v110, v110
    ds_read_b32 v111, v111
    ds_read_b32 v112, v112
    ds_read_b32 v113, v113
    ds_read_b32 v114, v114
    ds_read_b32 v115, v115
    ds_read_b32 v116, v116
    s_waitcnt lgkmcnt(15)
    v_cvt_pk_bf16_f32 v118, v100, v101
    s_waitcnt lgkmcnt(13)
    v_cvt_pk_bf16_f32 v119, v102, v103
    s_waitcnt lgkmcnt(11)
    v_cvt_pk_bf16_f32 v120, v104, v105
    s_waitcnt lgkmcnt(9)
    v_cvt_pk_bf16_f32 v121, v106, v107
    s_waitcnt lgkmcnt(7)
    v_cvt_pk_bf16_f32 v122, v108, v109
    s_waitcnt lgkmcnt(5)
    v_cvt_pk_bf16_f32 v123, v110, v111
    s_waitcnt lgkmcnt(3)
    v_cvt_pk_bf16_f32 v124, v112, v113
    s_waitcnt lgkmcnt(1)
    v_cvt_pk_bf16_f32 v125, v114, v115
    ds_write_b128 v96, v[118:121] offset:0
    ds_write_b128 v96, v[122:125] offset:16
    v_cvt_pk_bf16_f32 v126, v101, v102
    v_cvt_pk_bf16_f32 v127, v103, v104
    v_cvt_pk_bf16_f32 v128, v105, v106
    v_cvt_pk_bf16_f32 v129, v107, v108
    v_cvt_pk_bf16_f32 v130, v109, v110
    v_cvt_pk_bf16_f32 v131, v111, v112
    v_cvt_pk_bf16_f32 v132, v113, v114
    s_waitcnt lgkmcnt(2)
    v_cvt_pk_bf16_f32 v133, v115, v116
    ds_write_b128 v96, v[126:129] offset:4160
    ds_write_b128 v96, v[130:133] offset:4176
    s_waitcnt vmcnt(7)
    s_barrier
    ds_read_b64_tr_b16 a[64:65], v3 offset:0
    ds_read_b64_tr_b16 a[66:67], v3 offset:2048
    ds_read_b64_tr_b16 a[68:69], v3 offset:4096
    ds_read_b64_tr_b16 a[70:71], v3 offset:6144
    ds_read_b64_tr_b16 a[72:73], v3 offset:8192
    ds_read_b64_tr_b16 a[74:75], v3 offset:10240
    ds_read_b64_tr_b16 a[76:77], v3 offset:12288
    ds_read_b64_tr_b16 a[78:79], v3 offset:14336
    ds_read_b64_tr_b16 a[80:81], v3 offset:16384
    ds_read_b64_tr_b16 a[82:83], v3 offset:18432
    ds_read_b64_tr_b16 a[84:85], v3 offset:20480
    ds_read_b64_tr_b16 a[86:87], v3 offset:22528
    ds_read_b64_tr_b16 a[88:89], v3 offset:24576
    ds_read_b64_tr_b16 a[90:91], v3 offset:26624
    ds_read_b64_tr_b16 a[92:93], v3 offset:28672
    ds_read_b64_tr_b16 a[94:95], v3 offset:30720
    ds_read_b64_tr_b16 a[96:97], v3 offset:32768
    ds_read_b64_tr_b16 a[98:99], v3 offset:34816
    ds_read_b64_tr_b16 a[100:101], v3 offset:36864
    ds_read_b64_tr_b16 a[102:103], v3 offset:38912
    ds_read_b64_tr_b16 a[104:105], v3 offset:40960
    ds_read_b64_tr_b16 a[106:107], v3 offset:43008
    ds_read_b64_tr_b16 a[108:109], v3 offset:45056
    ds_read_b64_tr_b16 a[110:111], v3 offset:47104
    ds_read_b64_tr_b16 a[112:113], v3 offset:49152
    ds_read_b64_tr_b16 a[114:115], v3 offset:51200
    ds_read_b64_tr_b16 a[116:117], v3 offset:53248
    ds_read_b64_tr_b16 a[118:119], v3 offset:55296
    ds_read_b64_tr_b16 a[120:121], v3 offset:57344
    ds_read_b64_tr_b16 a[122:123], v3 offset:59392
    ds_read_b64_tr_b16 a[124:125], v3 offset:61440
    ds_read_b64_tr_b16 a[126:127], v3 offset:63488
    s_waitcnt vmcnt(6)
    v_pk_mul_f32 v[64:65], v[64:65], s[62:63] op_sel:[0,0] op_sel_hi:[1,0]
    v_pk_mul_f32 v[66:67], v[66:67], s[62:63] op_sel:[0,0] op_sel_hi:[1,0]
    s_waitcnt vmcnt(5)
    v_pk_fma_f32 v[72:73], v[72:73], s[62:63], s[62:63] op_sel:[0,0,1] op_sel_hi:[1,0,1]
    v_pk_fma_f32 v[74:75], v[74:75], s[62:63], s[62:63] op_sel:[0,0,1] op_sel_hi:[1,0,1]
    v_pk_fma_f32 v[72:73], v[64:65], v[64:65], v[72:73] op_sel:[0,0,0] op_sel_hi:[1,1,1] neg_lo:[1,0,0] neg_hi:[1,0,0]
    v_pk_fma_f32 v[74:75], v[66:67], v[66:67], v[74:75] op_sel:[0,0,0] op_sel_hi:[1,1,1] neg_lo:[1,0,0] neg_hi:[1,0,0]
    v_max_f32 v72, s63, v72
    v_max_f32 v73, s63, v73
    v_max_f32 v74, s63, v74
    v_max_f32 v75, s63, v75
    v_rsq_f32 v72, v72
    v_rsq_f32 v73, v73
    v_rsq_f32 v74, v74
    v_rsq_f32 v75, v75
    s_waitcnt vmcnt(4)
    v_lshlrev_b32 v100, 16, v50
    v_lshlrev_b32 v101, 16, v51
    v_lshlrev_b32 v102, 16, v52
    v_lshlrev_b32 v103, 16, v53
    v_pk_add_f32 v[58:59], v[100:101], v[64:65] op_sel:[0,0] op_sel_hi:[1,1] neg_lo:[0,1] neg_hi:[0,1]
    v_pk_add_f32 v[60:61], v[102:103], v[66:67] op_sel:[0,0] op_sel_hi:[1,1] neg_lo:[0,1] neg_hi:[0,1]
    v_pk_mul_f32 v[58:59], v[58:59], v[72:73] op_sel:[0,0] op_sel_hi:[1,1]
    v_pk_mul_f32 v[60:61], v[60:61], v[74:75] op_sel:[0,0] op_sel_hi:[1,1]
    v_cvt_pk_bf16_f32 v84, v58, v59
    v_cvt_pk_bf16_f32 v85, v60, v61
    ds_write_b64 v11, v[84:85] offset:0
    v_pk_fma_f32 v[100:101], v[58:59], s[56:57], v[100:101] op_sel:[0,0,0] op_sel_hi:[1,0,1]
    v_pk_fma_f32 v[102:103], v[60:61], s[56:57], v[102:103] op_sel:[0,0,0] op_sel_hi:[1,0,1]
    v_and_b32 v104, 0xffff0000, v50
    v_and_b32 v105, 0xffff0000, v51
    v_and_b32 v106, 0xffff0000, v52
    v_and_b32 v107, 0xffff0000, v53
    v_pk_add_f32 v[58:59], v[104:105], v[64:65] op_sel:[0,0] op_sel_hi:[1,1] neg_lo:[0,1] neg_hi:[0,1]
    v_pk_add_f32 v[60:61], v[106:107], v[66:67] op_sel:[0,0] op_sel_hi:[1,1] neg_lo:[0,1] neg_hi:[0,1]
    v_pk_mul_f32 v[58:59], v[58:59], v[72:73] op_sel:[0,0] op_sel_hi:[1,1]
    v_pk_mul_f32 v[60:61], v[60:61], v[74:75] op_sel:[0,0] op_sel_hi:[1,1]
    v_cvt_pk_bf16_f32 v86, v58, v59
    v_cvt_pk_bf16_f32 v87, v60, v61
    ds_write_b64 v11, v[86:87] offset:4608
    v_pk_fma_f32 v[104:105], v[58:59], s[56:57], v[104:105] op_sel:[0,1,0] op_sel_hi:[1,1,1]
    v_pk_fma_f32 v[106:107], v[60:61], s[56:57], v[106:107] op_sel:[0,1,0] op_sel_hi:[1,1,1]
    s_waitcnt vmcnt(3)
    v_pk_mul_f32 v[68:69], v[68:69], s[62:63] op_sel:[0,0] op_sel_hi:[1,0]
    v_pk_mul_f32 v[70:71], v[70:71], s[62:63] op_sel:[0,0] op_sel_hi:[1,0]
    s_waitcnt vmcnt(2)
    v_pk_fma_f32 v[76:77], v[76:77], s[62:63], s[62:63] op_sel:[0,0,1] op_sel_hi:[1,0,1]
    v_pk_fma_f32 v[78:79], v[78:79], s[62:63], s[62:63] op_sel:[0,0,1] op_sel_hi:[1,0,1]
    v_pk_fma_f32 v[76:77], v[68:69], v[68:69], v[76:77] op_sel:[0,0,0] op_sel_hi:[1,1,1] neg_lo:[1,0,0] neg_hi:[1,0,0]
    v_pk_fma_f32 v[78:79], v[70:71], v[70:71], v[78:79] op_sel:[0,0,0] op_sel_hi:[1,1,1] neg_lo:[1,0,0] neg_hi:[1,0,0]
    v_max_f32 v76, s63, v76
    v_max_f32 v77, s63, v77
    v_max_f32 v78, s63, v78
    v_max_f32 v79, s63, v79
    v_rsq_f32 v76, v76
    v_rsq_f32 v77, v77
    v_rsq_f32 v78, v78
    v_rsq_f32 v79, v79
    s_waitcnt vmcnt(1)
    v_lshlrev_b32 v108, 16, v54
    v_lshlrev_b32 v109, 16, v55
    v_lshlrev_b32 v110, 16, v56
    v_lshlrev_b32_e64 v111, 16, v57
    v_pk_add_f32 v[58:59], v[108:109], v[68:69] op_sel:[0,0] op_sel_hi:[1,1] neg_lo:[0,1] neg_hi:[0,1]
    v_pk_add_f32 v[60:61], v[110:111], v[70:71] op_sel:[0,0] op_sel_hi:[1,1] neg_lo:[0,1] neg_hi:[0,1]
    v_pk_mul_f32 v[58:59], v[58:59], v[76:77] op_sel:[0,0] op_sel_hi:[1,1]
    v_pk_mul_f32 v[60:61], v[60:61], v[78:79] op_sel:[0,0] op_sel_hi:[1,1]
    v_cvt_pk_bf16_f32 v84, v58, v59
    v_cvt_pk_bf16_f32 v85, v60, v61
    ds_write_b64 v11, v[84:85] offset:512
    v_pk_fma_f32 v[108:109], v[58:59], s[56:57], v[108:109] op_sel:[0,0,0] op_sel_hi:[1,0,1]
    v_pk_fma_f32 v[110:111], v[60:61], s[56:57], v[110:111] op_sel:[0,0,0] op_sel_hi:[1,0,1]
    v_and_b32 v112, 0xffff0000, v54
    v_and_b32 v113, 0xffff0000, v55
    v_and_b32 v114, 0xffff0000, v56
    v_and_b32 v115, 0xffff0000, v57
    v_pk_add_f32 v[58:59], v[112:113], v[68:69] op_sel:[0,0] op_sel_hi:[1,1] neg_lo:[0,1] neg_hi:[0,1]
    v_pk_add_f32 v[60:61], v[114:115], v[70:71] op_sel:[0,0] op_sel_hi:[1,1] neg_lo:[0,1] neg_hi:[0,1]
    v_pk_mul_f32 v[58:59], v[58:59], v[76:77] op_sel:[0,0] op_sel_hi:[1,1]
    v_pk_mul_f32 v[60:61], v[60:61], v[78:79] op_sel:[0,0] op_sel_hi:[1,1]
    v_cvt_pk_bf16_f32 v86, v58, v59
    v_cvt_pk_bf16_f32 v87, v60, v61
    ds_write_b64 v11, v[86:87] offset:5120
    v_pk_fma_f32 v[112:113], v[58:59], s[56:57], v[112:113] op_sel:[0,1,0] op_sel_hi:[1,1,1]
    v_pk_fma_f32 v[114:115], v[60:61], s[56:57], v[114:115] op_sel:[0,1,0] op_sel_hi:[1,1,1]
    s_and_b32 s53, s48, 1
    s_mul_i32 s53, s53, 768
    v_add_u32 v66, s53, v16
    v_add_u32 v67, 157440, v2
    s_waitcnt lgkmcnt(0)
    s_barrier
    ds_read2_b32 v[84:85], v12 offset0:176 offset1:177
    ds_read2_b32 v[86:87], v12 offset0:178 offset1:179
    ds_read_b128 v[88:91], v16 offset:192
    ds_read2_b32 v[92:93], v12 offset0:48 offset1:49
    ds_read2_b32 v[94:95], v12 offset0:50 offset1:51
    ds_read2_b32 v[148:149], v13 offset0:176 offset1:177
    ds_read2_b32 v[150:151], v13 offset0:178 offset1:179
    ds_read2_b32 v[152:153], v13 offset0:48 offset1:49
    ds_read2_b32 v[154:155], v13 offset0:50 offset1:51
    ds_read2_b32 v[156:157], v14 offset0:176 offset1:177
    ds_read2_b32 v[158:159], v14 offset0:178 offset1:179
    ds_read_b128 v[160:163], v16 offset:704
    s_waitcnt lgkmcnt(9)
    v_mfma_f32_16x16x32_bf16 v[116:119], v[84:87], v[88:91], 0
    ds_read_b128 v[164:167], v16 offset:1216
    s_waitcnt lgkmcnt(8)
    v_mfma_f32_16x16x32_bf16 v[120:123], v[92:95], v[88:91], 0
    ds_read_b128 v[168:171], v16 offset:1728
    s_waitcnt lgkmcnt(7)
    v_mfma_f32_16x16x32_bf16 v[124:127], v[148:151], v[88:91], 0
    ds_read_b128 v[172:175], v16 offset:2240
    s_waitcnt lgkmcnt(6)
    v_mfma_f32_16x16x32_bf16 v[128:131], v[152:155], v[88:91], 0
    ds_read_b128 v[176:179], v16 offset:2752
    s_waitcnt lgkmcnt(5)
    v_mfma_f32_16x16x32_bf16 v[132:135], v[156:159], v[88:91], 0
    s_mov_b32 s55, 0x600000
    s_waitcnt lgkmcnt(4)
    v_mfma_f32_16x16x32_bf16 v[120:123], v[84:87], v[160:163], v[120:123]
    buffer_store_dwordx2 v[80:81], v19, s[36:39], s55 offen offset:0 sc1
    v_mfma_f32_16x16x32_bf16 v[124:127], v[92:95], v[160:163], v[124:127]
    ds_read_b128 v[180:183], v16 offset:3264
    v_mfma_f32_16x16x32_bf16 v[128:131], v[148:151], v[160:163], v[128:131]
    ds_read_b128 v[184:187], v16 offset:3776
    v_mfma_f32_16x16x32_bf16 v[132:135], v[152:155], v[160:163], v[132:135]
    buffer_store_dwordx2 v[80:81], v19, s[36:39], s55 offen offset:128 sc1
    v_mfma_f32_16x16x32_bf16 v[136:139], v[156:159], v[160:163], 0
    ds_read_b128 v[188:191], v67 offset:0
    s_waitcnt lgkmcnt(6)
    v_mfma_f32_16x16x32_bf16 v[124:127], v[84:87], v[164:167], v[124:127]
    ds_read_b128 v[88:91], v66 offset:176
    s_nop 0
    s_mov_b32 s55, 0x640000
    v_mfma_f32_16x16x32_bf16 v[128:131], v[92:95], v[164:167], v[128:131]
    buffer_store_dwordx2 v[80:81], v19, s[36:39], s55 offen offset:0 sc1
    v_mfma_f32_16x16x32_bf16 v[132:135], v[148:151], v[164:167], v[132:135]
    ds_read_b128 v[160:163], v67 offset:1024
    v_mfma_f32_16x16x32_bf16 v[136:139], v[152:155], v[164:167], v[136:139]
    v_mfma_f32_16x16x32_bf16 v[140:143], v[156:159], v[164:167], 0
    buffer_store_dwordx2 v[80:81], v19, s[36:39], s55 offen offset:128 sc1
    s_waitcnt lgkmcnt(7)
    v_mfma_f32_16x16x32_bf16 v[128:131], v[84:87], v[168:171], v[128:131]
    ds_read_b128 v[164:167], v66 offset:192
    v_mfma_f32_16x16x32_bf16 v[132:135], v[92:95], v[168:171], v[132:135]
    s_mul_i32 s16, s48, 16384
    v_mfma_f32_16x16x32_bf16 v[136:139], v[148:151], v[168:171], v[136:139]
    s_add_u32 m0, s16, 0
    v_mfma_f32_16x16x32_bf16 v[140:143], v[152:155], v[168:171], v[140:143]
    s_mul_i32 s3, s48, 393216
    v_mfma_f32_16x16x32_bf16 v[144:147], v[156:159], v[168:171], 0
    ds_read_b128 v[156:159], v66 offset:1200
    s_add_u32 s3, s3, 2048
    s_waitcnt lgkmcnt(8)
    v_mfma_f32_16x16x32_bf16 v[132:135], v[84:87], v[172:175], v[132:135]
    s_nop 0
    buffer_load_dwordx4 v36, s[40:43], s3 offen offset:0 lds
    v_mfma_f32_16x16x32_bf16 v[136:139], v[92:95], v[172:175], v[136:139]
    ds_read_b128 v[168:171], v66 offset:1216
    v_mfma_f32_16x16x32_bf16 v[140:143], v[148:151], v[172:175], v[140:143]
    v_mfma_f32_16x16x32_bf16 v[144:147], v[152:155], v[172:175], v[144:147]
    ds_read2_b32 v[152:153], v12 offset0:160 offset1:161
    s_waitcnt lgkmcnt(9)
    v_mfma_f32_16x16x32_bf16 v[136:139], v[84:87], v[176:179], v[136:139]
    ds_read2_b32 v[154:155], v12 offset0:162 offset1:163
    s_add_u32 s3, s3, 23552
    v_mfma_f32_16x16x32_bf16 v[140:143], v[92:95], v[176:179], v[140:143]
    buffer_load_dwordx4 v36, s[40:43], s3 offen offset:1024 lds
    v_mfma_f32_16x16x32_bf16 v[144:147], v[148:151], v[176:179], v[144:147]
    ds_read_b128 v[172:175], v16 offset:128
    s_waitcnt lgkmcnt(10)
    v_mfma_f32_16x16x32_bf16 v[140:143], v[84:87], v[180:183], v[140:143]
    ds_read2_b32 v[148:149], v12 offset0:32 offset1:33
    v_mfma_f32_16x16x32_bf16 v[144:147], v[92:95], v[180:183], v[144:147]
    ds_read2_b32 v[150:151], v12 offset0:34 offset1:35
    s_waitcnt lgkmcnt(11)
    v_mfma_f32_16x16x32_bf16 v[144:147], v[84:87], v[184:187], v[144:147]
    ds_read2_b32 v[176:177], v13 offset0:160 offset1:161
    s_waitcnt lgkmcnt(10)
    v_mfma_f32_16x16x32_bf16 v[50:53], v[88:91], v[188:191], 0
    ds_read2_b32 v[178:179], v13 offset0:162 offset1:163
    s_add_u32 s3, s3, 23552
    s_waitcnt lgkmcnt(9)
    v_mfma_f32_16x16x32_bf16 v[54:57], v[164:167], v[160:163], 0
    buffer_load_dwordx4 v36, s[40:43], s3 offen offset:2048 lds
    s_waitcnt lgkmcnt(8)
    v_mfma_f32_16x16x32_bf16 v[58:61], v[156:159], v[188:191], 0
    ds_read2_b32 v[92:93], v13 offset0:32 offset1:33
    s_waitcnt lgkmcnt(8)
    v_mfma_f32_16x16x32_bf16 v[62:65], v[168:171], v[160:163], 0
    ds_read2_b32 v[94:95], v13 offset0:34 offset1:35
    s_waitcnt lgkmcnt(6)
    v_mfma_f32_16x16x32_bf16 v[116:119], v[152:155], v[172:175], v[116:119]
    ds_read_b128 v[180:183], v16 offset:640
    s_waitcnt lgkmcnt(5)
    v_mfma_f32_16x16x32_bf16 v[120:123], v[148:151], v[172:175], v[120:123]
    ds_read_b128 v[84:87], v16 offset:1152
    s_waitcnt lgkmcnt(4)
    v_mfma_f32_16x16x32_bf16 v[124:127], v[176:179], v[172:175], v[124:127]
    ds_read_b128 v[184:187], v16 offset:1664
    s_add_u32 s3, s3, 23552
    s_waitcnt lgkmcnt(3)
    v_mfma_f32_16x16x32_bf16 v[128:131], v[92:95], v[172:175], v[128:131]
    buffer_load_dwordx4 v36, s[40:43], s3 offen offset:3072 lds
    s_waitcnt lgkmcnt(2)
    v_mfma_f32_16x16x32_bf16 v[120:123], v[152:155], v[180:183], v[120:123]
    ds_read_b128 v[88:91], v16 offset:2176
    v_mfma_f32_16x16x32_bf16 v[124:127], v[148:151], v[180:183], v[124:127]
    ds_read_b128 v[164:167], v16 offset:2688
    v_mfma_f32_16x16x32_bf16 v[128:131], v[176:179], v[180:183], v[128:131]
    ds_read_b128 v[188:191], v16 offset:3200
    v_cvt_pk_bf16_f32 v50, v50, v54
    v_mfma_f32_16x16x32_bf16 v[132:135], v[92:95], v[180:183], v[132:135]
    ds_read_b128 v[156:159], v16 offset:3712
    v_cvt_pk_bf16_f32 v51, v51, v55
    s_add_u32 m0, s16, 4096
    s_waitcnt lgkmcnt(5)
    v_mfma_f32_16x16x32_bf16 v[124:127], v[152:155], v[84:87], v[124:127]
    ds_read2_b32 v[160:161], v15 offset0:48 offset1:49
    s_nop 0
    v_cvt_pk_bf16_f32 v52, v52, v56
    s_add_u32 s3, s3, 27648
    v_mfma_f32_16x16x32_bf16 v[128:131], v[148:151], v[84:87], v[128:131]
    v_cvt_pk_bf16_f32 v53, v53, v57
    buffer_load_dwordx4 v36, s[40:43], s3 offen offset:0 lds
    v_mfma_f32_16x16x32_bf16 v[132:135], v[176:179], v[84:87], v[132:135]
    ds_read2_b32 v[162:163], v15 offset0:50 offset1:51
    v_cvt_pk_bf16_f32 v58, v58, v62
    v_mfma_f32_16x16x32_bf16 v[136:139], v[92:95], v[84:87], v[136:139]
    ds_read2_b32 v[168:169], v15 offset0:32 offset1:33
    v_cvt_pk_bf16_f32 v59, v59, v63
    s_waitcnt lgkmcnt(7)
    v_mfma_f32_16x16x32_bf16 v[128:131], v[152:155], v[184:187], v[128:131]
    ds_read2_b32 v[170:171], v15 offset0:34 offset1:35
    s_nop 0
    v_cvt_pk_bf16_f32 v60, v60, v64
    v_mfma_f32_16x16x32_bf16 v[132:135], v[148:151], v[184:187], v[132:135]
    ds_read2_b32 v[172:173], v15 offset0:16 offset1:17
    v_cvt_pk_bf16_f32 v61, v61, v65
    v_mfma_f32_16x16x32_bf16 v[136:139], v[176:179], v[184:187], v[136:139]
    ds_read2_b32 v[174:175], v15 offset0:18 offset1:19
    s_add_u32 s3, s3, 23552
    v_mfma_f32_16x16x32_bf16 v[140:143], v[92:95], v[184:187], v[140:143]
    buffer_load_dwordx4 v36, s[40:43], s3 offen offset:1024 lds
    s_waitcnt lgkmcnt(9)
    v_mfma_f32_16x16x32_bf16 v[132:135], v[152:155], v[88:91], v[132:135]
    ds_read2_b32 v[180:181], v15 offset0:0 offset1:1
    s_waitcnt vmcnt(10)
    v_mfma_f32_16x16x32_bf16 v[136:139], v[148:151], v[88:91], v[136:139]
    ds_read2_b32 v[182:183], v15 offset0:2 offset1:3
    ds_read_b64_tr_b16 v[68:69], v98 offset:0
    v_mfma_f32_16x16x32_bf16 v[140:143], v[176:179], v[88:91], v[140:143]
    ds_read2_b32 v[84:85], v12 offset0:144 offset1:145
    ds_read_b64_tr_b16 v[70:71], v98 offset:512
    v_mfma_f32_16x16x32_bf16 v[144:147], v[92:95], v[88:91], v[144:147]
    ds_read2_b32 v[86:87], v12 offset0:146 offset1:147
    s_waitcnt lgkmcnt(14)
    v_mfma_f32_16x16x32_bf16 v[136:139], v[152:155], v[164:167], v[136:139]
    ds_read_b128 v[184:187], v16 offset:64
    s_add_u32 s3, s3, 23552
    v_mfma_f32_16x16x32_bf16 v[140:143], v[148:151], v[164:167], v[140:143]
    buffer_load_dwordx4 v36, s[40:43], s3 offen offset:2048 lds
    v_mfma_f32_16x16x32_bf16 v[144:147], v[176:179], v[164:167], v[144:147]
    ds_read2_b32 v[92:93], v12 offset0:16 offset1:17
    s_waitcnt lgkmcnt(15)
    v_mfma_f32_16x16x32_bf16 v[140:143], v[152:155], v[188:191], v[140:143]
    ds_read2_b32 v[94:95], v12 offset0:18 offset1:19
    v_mfma_f32_16x16x32_bf16 v[144:147], v[148:151], v[188:191], v[144:147]
    ds_read2_b32 v[88:89], v13 offset0:144 offset1:145
    s_waitcnt lgkmcnt(15)
    v_mfma_f32_16x16x32_bf16 v[144:147], v[152:155], v[156:159], v[144:147]
    ds_read2_b32 v[90:91], v13 offset0:146 offset1:147
    s_waitcnt lgkmcnt(15)
    v_mfma_f32_16x16x32_bf16 v[132:135], v[50:53], v[160:163], v[132:135]
    ds_read2_b32 v[176:177], v13 offset0:16 offset1:17
    s_add_u32 s3, s3, 23552
    v_mfma_f32_16x16x32_bf16 v[140:143], v[58:61], v[160:163], v[140:143]
    buffer_load_dwordx4 v36, s[40:43], s3 offen offset:3072 lds
    s_waitcnt lgkmcnt(14)
    v_mfma_f32_16x16x32_bf16 v[136:139], v[50:53], v[168:171], v[136:139]
    ds_read2_b32 v[178:179], v13 offset0:18 offset1:19
    s_waitcnt lgkmcnt(8)
    buffer_store_dwordx4 v[68:71], v2, s[36:39], s1 offen sc1
    v_mfma_f32_16x16x32_bf16 v[144:147], v[58:61], v[168:171], v[144:147]
    ds_read_b128 v[164:167], v16 offset:576
    v_mfma_f32_16x16x32_bf16 v[72:75], v[46:49], v[68:71], 0
    v_mfma_f32_16x16x32_bf16 v[140:143], v[50:53], v[172:175], v[140:143]
    ds_read_b128 v[148:151], v16 offset:1088
    s_bfe_u32 s54, s1, 0x5000a
    v_mfma_f32_16x16x32_bf16 v[144:147], v[50:53], v[180:183], v[144:147]
    ds_read_b128 v[188:191], v16 offset:1600
    s_add_u32 m0, s16, 8192
    s_lshl_b32 s54, s54, 8
    s_waitcnt lgkmcnt(9)
    v_mfma_f32_16x16x32_bf16 v[116:119], v[84:87], v[184:187], v[116:119]
    ds_read_b128 v[152:155], v16 offset:2112
    s_add_u32 s3, s3, 27648
    s_add_u32 s54, s54, 0x2d000
    s_waitcnt lgkmcnt(8)
    v_mfma_f32_16x16x32_bf16 v[120:123], v[92:95], v[184:187], v[120:123]
    buffer_load_dwordx4 v36, s[40:43], s3 offen offset:0 lds
    v_lshlrev_b32 v76, 2, v1
    s_waitcnt lgkmcnt(6)
    v_mfma_f32_16x16x32_bf16 v[124:127], v[88:91], v[184:187], v[124:127]
    ds_read_b128 v[156:159], v16 offset:2624
    s_waitcnt lgkmcnt(5)
    v_mfma_f32_16x16x32_bf16 v[128:131], v[176:179], v[184:187], v[128:131]
    ds_read_b128 v[160:163], v16 offset:3136
    s_waitcnt lgkmcnt(5)
    v_mfma_f32_16x16x32_bf16 v[120:123], v[84:87], v[164:167], v[120:123]
    ds_read_b128 v[168:171], v16 offset:3648
    v_mfma_f32_16x16x32_bf16 v[124:127], v[92:95], v[164:167], v[124:127]
    s_add_u32 s3, s3, 23552
    s_cmp_ge_u32 s2, 128
    s_cbranch_scc1 L_nocs
    s_mov_b64 exec, 0xffff
    buffer_atomic_add_f32 v72, v76, s[36:39], s54 offen
    s_mov_b64 exec, -1
L_nocs:
    v_mfma_f32_16x16x32_bf16 v[128:131], v[88:91], v[164:167], v[128:131]
    buffer_load_dwordx4 v36, s[40:43], s3 offen offset:1024 lds
    v_mfma_f32_16x16x32_bf16 v[132:135], v[176:179], v[164:167], v[132:135]
    ds_read2_b32 v[172:173], v12 offset0:128 offset1:129
    s_waitcnt lgkmcnt(6)
    v_mfma_f32_16x16x32_bf16 v[124:127], v[84:87], v[148:151], v[124:127]
    ds_read2_b32 v[174:175], v12 offset0:130 offset1:131
    v_mfma_f32_16x16x32_bf16 v[128:131], v[92:95], v[148:151], v[128:131]
    ds_read_b128 v[180:183], v16 offset:0
    v_mfma_f32_16x16x32_bf16 v[132:135], v[88:91], v[148:151], v[132:135]
    ds_read2_b32 v[184:185], v12 offset0:0 offset1:1
    s_lshl4_add_u32 s54, s49, s50
    v_mfma_f32_16x16x32_bf16 v[136:139], v[176:179], v[148:151], v[136:139]
    ds_read2_b32 v[186:187], v12 offset0:2 offset1:3
    s_lshl2_add_u32 s54, s54, s48
    s_add_u32 s3, s3, 23552
    s_waitcnt lgkmcnt(9)
    v_mfma_f32_16x16x32_bf16 v[128:131], v[84:87], v[188:191], v[128:131]
    s_lshl_b32 s54, s54, 10
    buffer_load_dwordx4 v36, s[40:43], s3 offen offset:2048 lds
    v_mfma_f32_16x16x32_bf16 v[132:135], v[92:95], v[188:191], v[132:135]
    ds_read_b128 v[164:167], v16 offset:512
    s_add_u32 s54, s54, 0xa00000
    v_mfma_f32_16x16x32_bf16 v[136:139], v[88:91], v[188:191], v[136:139]
    buffer_store_dwordx4 v[80:83], v2, s[36:39], s54 offen sc1
    v_mfma_f32_16x16x32_bf16 v[140:143], v[176:179], v[188:191], v[140:143]
    ds_read2_b32 v[148:149], v13 offset0:128 offset1:129
    s_waitcnt lgkmcnt(10)
    v_mfma_f32_16x16x32_bf16 v[132:135], v[84:87], v[152:155], v[132:135]
    ds_read2_b32 v[150:151], v13 offset0:130 offset1:131
    v_mfma_f32_16x16x32_bf16 v[136:139], v[92:95], v[152:155], v[136:139]
    ds_read_b128 v[188:191], v16 offset:1024
    s_nop 0
    s_add_u32 s3, s3, 23552
    v_mfma_f32_16x16x32_bf16 v[140:143], v[88:91], v[152:155], v[140:143]
    s_add_u32 s54, s54, 0x8000
    buffer_load_dwordx4 v36, s[40:43], s3 offen offset:3072 lds
    v_mfma_f32_16x16x32_bf16 v[144:147], v[176:179], v[152:155], v[144:147]
    buffer_store_dwordx4 v[80:83], v2, s[36:39], s54 offen sc1
    s_waitcnt lgkmcnt(11)
    v_mfma_f32_16x16x32_bf16 v[136:139], v[84:87], v[156:159], v[136:139]
    ds_read2_b32 v[176:177], v13 offset0:0 offset1:1
    v_mfma_f32_16x16x32_bf16 v[140:143], v[92:95], v[156:159], v[140:143]
    ds_read2_b32 v[178:179], v13 offset0:2 offset1:3
    v_mfma_f32_16x16x32_bf16 v[144:147], v[88:91], v[156:159], v[144:147]
    ds_read_b128 v[152:155], v16 offset:1536
    s_add_u32 m0, s16, 12288
    s_waitcnt lgkmcnt(13)
    v_mfma_f32_16x16x32_bf16 v[140:143], v[84:87], v[160:163], v[140:143]
    ds_read_b128 v[88:91], v16 offset:2048
    s_add_u32 s3, s3, 27648
    v_mfma_f32_16x16x32_bf16 v[144:147], v[92:95], v[160:163], v[144:147]
    buffer_load_dwordx4 v36, s[40:43], s3 offen offset:0 lds
    s_waitcnt lgkmcnt(13)
    v_mfma_f32_16x16x32_bf16 v[144:147], v[84:87], v[168:171], v[144:147]
    ds_read_b128 v[156:159], v16 offset:2560
    s_waitcnt lgkmcnt(11)
    v_mfma_f32_16x16x32_bf16 v[116:119], v[172:175], v[180:183], v[116:119]
    ds_read_b128 v[92:95], v16 offset:3072
    s_waitcnt lgkmcnt(10)
    v_mfma_f32_16x16x32_bf16 v[120:123], v[184:187], v[180:183], v[120:123]
    s_waitcnt lgkmcnt(9)
    v_mfma_f32_16x16x32_bf16 v[120:123], v[172:175], v[164:167], v[120:123]
    s_waitcnt lgkmcnt(7)
    v_mfma_f32_16x16x32_bf16 v[124:127], v[148:151], v[180:183], v[124:127]
    ds_read_b128 v[160:163], v16 offset:3584
    s_add_u32 s3, s3, 23552
    v_mfma_f32_16x16x32_bf16 v[124:127], v[184:187], v[164:167], v[124:127]
    buffer_load_dwordx4 v36, s[40:43], s3 offen offset:1024 lds
    s_waitcnt lgkmcnt(7)
    v_mfma_f32_16x16x32_bf16 v[124:127], v[172:175], v[188:191], v[124:127]
    ds_write_b128 v17, v[116:119] offset:0
    s_waitcnt lgkmcnt(6)
    v_mfma_f32_16x16x32_bf16 v[128:131], v[176:179], v[180:183], v[128:131]
    v_mfma_f32_16x16x32_bf16 v[128:131], v[148:151], v[164:167], v[128:131]
    ds_write_b128 v17, v[120:123] offset:1280
    v_mfma_f32_16x16x32_bf16 v[128:131], v[184:187], v[188:191], v[128:131]
    s_waitcnt lgkmcnt(6)
    v_mfma_f32_16x16x32_bf16 v[128:131], v[172:175], v[152:155], v[128:131]
    s_add_u32 s3, s3, 23552
    v_mfma_f32_16x16x32_bf16 v[132:135], v[176:179], v[164:167], v[132:135]
    ds_write_b128 v17, v[124:127] offset:2560
    buffer_load_dwordx4 v36, s[40:43], s3 offen offset:2048 lds
    v_mfma_f32_16x16x32_bf16 v[132:135], v[148:151], v[188:191], v[132:135]
    v_mfma_f32_16x16x32_bf16 v[132:135], v[184:187], v[152:155], v[132:135]
    s_waitcnt lgkmcnt(6)
    v_mfma_f32_16x16x32_bf16 v[132:135], v[172:175], v[88:91], v[132:135]
    v_mfma_f32_16x16x32_bf16 v[136:139], v[176:179], v[188:191], v[136:139]
    ds_write_b128 v17, v[128:131] offset:3840
    v_mfma_f32_16x16x32_bf16 v[136:139], v[148:151], v[152:155], v[136:139]
    s_add_u32 s3, s3, 23552
    v_mfma_f32_16x16x32_bf16 v[136:139], v[184:187], v[88:91], v[136:139]
    buffer_load_dwordx4 v36, s[40:43], s3 offen offset:3072 lds
    s_waitcnt lgkmcnt(6)
    v_mfma_f32_16x16x32_bf16 v[136:139], v[172:175], v[156:159], v[136:139]
    v_mfma_f32_16x16x32_bf16 v[140:143], v[176:179], v[152:155], v[140:143]
    ds_write_b128 v17, v[132:135] offset:5120
    v_mfma_f32_16x16x32_bf16 v[140:143], v[148:151], v[88:91], v[140:143]
    v_mfma_f32_16x16x32_bf16 v[140:143], v[184:187], v[156:159], v[140:143]
    s_waitcnt lgkmcnt(6)
    v_mfma_f32_16x16x32_bf16 v[140:143], v[172:175], v[92:95], v[140:143]
    v_mfma_f32_16x16x32_bf16 v[144:147], v[176:179], v[88:91], v[144:147]
    s_nop 0
    ds_write_b128 v17, v[136:139] offset:6400
    v_mfma_f32_16x16x32_bf16 v[144:147], v[148:151], v[156:159], v[144:147]
    v_mfma_f32_16x16x32_bf16 v[144:147], v[184:187], v[92:95], v[144:147]
    s_waitcnt lgkmcnt(6)
    v_mfma_f32_16x16x32_bf16 v[144:147], v[172:175], v[160:163], v[144:147]
    s_nop 0
    ds_write_b128 v17, v[140:143] offset:7680
    s_nop 5
    ds_write_b128 v17, v[144:147] offset:8960
    s_waitcnt vmcnt(9)
    s_waitcnt lgkmcnt(0)
    s_barrier
    s_cmp_lg_u32 s48, 0
    s_cbranch_scc1 L_arr1
    v_mov_b32 v50, 1
    s_mov_b32 exec_hi, 0
    buffer_atomic_add v50, v32, s[36:39], 0 offen
    s_mov_b64 exec, -1
L_arr1:
    ds_read_b128 v[50:53], v18 offset:0
    ds_read_b128 v[54:57], v18 offset:10240
    ds_read_b128 v[58:61], v18 offset:20480
    ds_read_b128 v[62:65], v18 offset:30720
    ds_read_b128 v[66:69], v18 offset:1280
    ds_read_b128 v[70:73], v18 offset:11520
    ds_read_b128 v[74:77], v18 offset:21760
    ds_read_b128 v[78:81], v18 offset:32000
    s_mov_b32 s53, 0x600000
    s_mov_b32 s54, 0x640000
    s_waitcnt lgkmcnt(7)
    v_pk_add_f32 v[100:101], v[100:101], v[50:51] op_sel:[0,0] op_sel_hi:[1,1]
    v_pk_add_f32 v[102:103], v[102:103], v[52:53] op_sel:[0,0] op_sel_hi:[1,1]
    s_waitcnt lgkmcnt(6)
    v_pk_add_f32 v[100:101], v[100:101], v[54:55] op_sel:[0,0] op_sel_hi:[1,1]
    v_pk_add_f32 v[102:103], v[102:103], v[56:57] op_sel:[0,0] op_sel_hi:[1,1]
    v_cvt_pk_bf16_f32 v50, v100, v101
    v_cvt_pk_bf16_f32 v51, v102, v103
    buffer_store_dwordx2 v[50:51], v19, s[36:39], s53 offen offset:0 sc1
    s_waitcnt lgkmcnt(5)
    v_pk_add_f32 v[104:105], v[104:105], v[58:59] op_sel:[0,0] op_sel_hi:[1,1]
    v_pk_add_f32 v[106:107], v[106:107], v[60:61] op_sel:[0,0] op_sel_hi:[1,1]
    s_waitcnt lgkmcnt(4)
    v_pk_add_f32 v[104:105], v[104:105], v[62:63] op_sel:[0,0] op_sel_hi:[1,1]
    v_pk_add_f32 v[106:107], v[106:107], v[64:65] op_sel:[0,0] op_sel_hi:[1,1]
    v_cvt_pk_bf16_f32 v58, v104, v105
    v_cvt_pk_bf16_f32 v59, v106, v107
    buffer_store_dwordx2 v[58:59], v19, s[36:39], s53 offen offset:128 sc1
    s_waitcnt lgkmcnt(3)
L_stub_s1_0:
    s_cbranch_execz L_tback_s1
    s_nop 0
    v_pk_add_f32 v[108:109], v[108:109], v[66:67] op_sel:[0,0] op_sel_hi:[1,1]
    v_pk_add_f32 v[110:111], v[110:111], v[68:69] op_sel:[0,0] op_sel_hi:[1,1]
    s_waitcnt lgkmcnt(2)
    v_pk_add_f32 v[108:109], v[108:109], v[70:71] op_sel:[0,0] op_sel_hi:[1,1]
    v_pk_add_f32 v[110:111], v[110:111], v[72:73] op_sel:[0,0] op_sel_hi:[1,1]
    v_cvt_pk_bf16_f32 v66, v108, v109
    v_cvt_pk_bf16_f32 v67, v110, v111
    buffer_store_dwordx2 v[66:67], v19, s[36:39], s54 offen offset:0 sc1
    s_waitcnt lgkmcnt(1)
    v_pk_add_f32 v[112:113], v[112:113], v[74:75] op_sel:[0,0] op_sel_hi:[1,1]
    v_pk_add_f32 v[114:115], v[114:115], v[76:77] op_sel:[0,0] op_sel_hi:[1,1]
    s_waitcnt lgkmcnt(0)
    v_pk_add_f32 v[112:113], v[112:113], v[78:79] op_sel:[0,0] op_sel_hi:[1,1]
    v_pk_add_f32 v[114:115], v[114:115], v[80:81] op_sel:[0,0] op_sel_hi:[1,1]
    v_cvt_pk_bf16_f32 v74, v112, v113
    v_cvt_pk_bf16_f32 v75, v114, v115
    buffer_store_dwordx2 v[74:75], v19, s[36:39], s54 offen offset:128 sc1
    s_waitcnt vmcnt(4)
    s_barrier
    s_cmp_lg_u32 s48, 0
    s_cbranch_scc1 L_ps2
    s_mov_b64 exec, 0xff
    v_mov_b32 v34, 0
    buffer_atomic_add v34, v33, s[36:39], 0 offen sc0
    s_mov_b64 exec, -1
L_ps2:
    ds_read_b64_tr_b16 a[128:129], v3 offset:0
    ds_read_b64_tr_b16 a[130:131], v3 offset:2048
    ds_read_b64_tr_b16 a[132:133], v3 offset:4096
    ds_read_b64_tr_b16 a[134:135], v3 offset:6144
    ds_read_b64_tr_b16 a[136:137], v3 offset:8192
    ds_read_b64_tr_b16 a[138:139], v3 offset:10240
    ds_read_b64_tr_b16 a[140:141], v3 offset:12288
    ds_read_b64_tr_b16 a[142:143], v3 offset:14336
    ds_read_b64_tr_b16 a[144:145], v3 offset:16384
    ds_read_b64_tr_b16 a[146:147], v3 offset:18432
    ds_read_b64_tr_b16 a[148:149], v3 offset:20480
    ds_read_b64_tr_b16 a[150:151], v3 offset:22528
    ds_read_b64_tr_b16 a[152:153], v3 offset:24576
    ds_read_b64_tr_b16 a[154:155], v3 offset:26624
    ds_read_b64_tr_b16 a[156:157], v3 offset:28672
    ds_read_b64_tr_b16 a[158:159], v3 offset:30720
    ds_read_b64_tr_b16 a[160:161], v3 offset:32768
    ds_read_b64_tr_b16 a[162:163], v3 offset:34816
    ds_read_b64_tr_b16 a[164:165], v3 offset:36864
    ds_read_b64_tr_b16 a[166:167], v3 offset:38912
    ds_read_b64_tr_b16 a[168:169], v3 offset:40960
    ds_read_b64_tr_b16 a[170:171], v3 offset:43008
    ds_read_b64_tr_b16 a[172:173], v3 offset:45056
    ds_read_b64_tr_b16 a[174:175], v3 offset:47104
    ds_read_b64_tr_b16 a[176:177], v3 offset:49152
    ds_read_b64_tr_b16 a[178:179], v3 offset:51200
    ds_read_b64_tr_b16 a[180:181], v3 offset:53248
    ds_read_b64_tr_b16 a[182:183], v3 offset:55296
    ds_read_b64_tr_b16 a[184:185], v3 offset:57344
    ds_read_b64_tr_b16 a[186:187], v3 offset:59392
    ds_read_b64_tr_b16 a[188:189], v3 offset:61440
    ds_read_b64_tr_b16 a[190:191], v3 offset:63488
    v_mfma_f32_16x16x32_bf16 v[50:53], v[46:49], a[64:67], 0
    v_mfma_f32_16x16x32_bf16 v[50:53], v[46:49], a[68:71], v[50:53]
    v_mfma_f32_16x16x32_bf16 v[50:53], v[46:49], a[72:75], v[50:53]
    v_mfma_f32_16x16x32_bf16 v[50:53], v[46:49], a[76:79], v[50:53]
    v_mfma_f32_16x16x32_bf16 v[50:53], v[46:49], a[80:83], v[50:53]
    v_mfma_f32_16x16x32_bf16 v[50:53], v[46:49], a[84:87], v[50:53]
    v_mfma_f32_16x16x32_bf16 v[50:53], v[46:49], a[88:91], v[50:53]
    v_mfma_f32_16x16x32_bf16 v[50:53], v[46:49], a[92:95], v[50:53]
    v_mfma_f32_16x16x32_bf16 v[50:53], v[46:49], a[96:99], v[50:53]
    v_mfma_f32_16x16x32_bf16 v[50:53], v[46:49], a[100:103], v[50:53]
    v_mfma_f32_16x16x32_bf16 v[50:53], v[46:49], a[104:107], v[50:53]
    v_mfma_f32_16x16x32_bf16 v[50:53], v[46:49], a[108:111], v[50:53]
    v_mfma_f32_16x16x32_bf16 v[50:53], v[46:49], a[112:115], v[50:53]
    v_mfma_f32_16x16x32_bf16 v[50:53], v[46:49], a[116:119], v[50:53]
    v_mfma_f32_16x16x32_bf16 v[50:53], v[46:49], a[120:123], v[50:53]
    v_mfma_f32_16x16x32_bf16 v[50:53], v[46:49], a[124:127], v[50:53]
    s_nop 7
    v_mov_b32 v40, v50
    s_mov_b32 s67, s48
    s_branch L_pg3
.p2align 12
L_pg3:
    s_cmp_lg_u32 s48, 0
    s_cbranch_scc0 L_wait2_w0
    s_mov_b64 exec, 0
    s_branch L_stub_s2_0
L_tback_s2:
    s_mov_b64 exec, -1
    s_nop 0
    s_branch L_wait2
L_wait2_w0:
    s_mov_b64 exec, 0xff
    s_movk_i32 s53, 64
    s_mov_b32 s61, 0x100000
L_wait2_poll:
    v_mov_b32_e64 v35, 0
    buffer_atomic_add v35, v33, s[36:39], 0 offen sc0
    s_waitcnt vmcnt(1)
    v_cmp_gt_u32 vcc, s53, v34
    s_cbranch_vccz L_wait2_done
    v_mov_b32 v34, 0
    buffer_atomic_add v34, v33, s[36:39], 0 offen sc0
    s_sub_u32 s61, s61, 1
    s_cbranch_scc1 L_wait2_done
    s_waitcnt vmcnt(1)
    v_cmp_gt_u32 vcc, s53, v35
    s_cbranch_vccnz L_wait2_poll
L_wait2_done:
    s_mov_b64 exec, -1
L_wait2:
    s_waitcnt lgkmcnt(0)
    s_barrier
L_redox0:
    s_lshl_b32 m0, s48, 10
    s_sub_u32 s69, 0x600000, s5
    buffer_load_dwordx4 v20, s[36:39], s69 offen offset:0 sc1 lds
    s_barrier
    s_add_u32 m0, m0, 4096
    s_add_u32 s69, s69, 4096
    buffer_load_dwordx4 v20, s[36:39], s69 offen offset:0 sc1 lds
    s_barrier
    s_nop 0
    s_add_u32 m0, m0, 4096
    s_add_u32 s69, s69, 4096
    buffer_load_dwordx4 v20, s[36:39], s69 offen offset:0 sc1 lds
    s_add_u32 m0, m0, 4096
    s_add_u32 s69, s69, 4096
    buffer_load_dwordx4 v20, s[36:39], s69 offen offset:0 sc1 lds
    s_barrier
    s_nop 0
    s_add_u32 m0, s4, 16384
    s_mov_b32 s69, 0x604000
    buffer_load_dwordx4 v20, s[36:39], s69 offen offset:0 sc1 lds
    buffer_load_dwordx4 v20, s[36:39], s69 offen offset:1024 sc1 lds
    buffer_load_dwordx4 v20, s[36:39], s69 offen offset:2048 sc1 lds
    buffer_load_dwordx4 v20, s[36:39], s69 offen offset:3072 sc1 lds
    v_mfma_f32_16x16x32_bf16 v[50:53], v[46:49], a[128:131], 0
    v_mfma_f32_16x16x32_bf16 v[50:53], v[46:49], a[132:135], v[50:53]
    v_mfma_f32_16x16x32_bf16 v[50:53], v[46:49], a[136:139], v[50:53]
    v_mfma_f32_16x16x32_bf16 v[50:53], v[46:49], a[140:143], v[50:53]
    v_mfma_f32_16x16x32_bf16 v[50:53], v[46:49], a[144:147], v[50:53]
    v_mfma_f32_16x16x32_bf16 v[50:53], v[46:49], a[148:151], v[50:53]
    v_mfma_f32_16x16x32_bf16 v[50:53], v[46:49], a[152:155], v[50:53]
    v_mfma_f32_16x16x32_bf16 v[50:53], v[46:49], a[156:159], v[50:53]
    v_mfma_f32_16x16x32_bf16 v[50:53], v[46:49], a[160:163], v[50:53]
    v_mfma_f32_16x16x32_bf16 v[50:53], v[46:49], a[164:167], v[50:53]
    v_mfma_f32_16x16x32_bf16 v[50:53], v[46:49], a[168:171], v[50:53]
    v_mfma_f32_16x16x32_bf16 v[50:53], v[46:49], a[172:175], v[50:53]
    v_mfma_f32_16x16x32_bf16 v[50:53], v[46:49], a[176:179], v[50:53]
    v_mfma_f32_16x16x32_bf16 v[50:53], v[46:49], a[180:183], v[50:53]
    v_mfma_f32_16x16x32_bf16 v[50:53], v[46:49], a[184:187], v[50:53]
    v_mfma_f32_16x16x32_bf16 v[50:53], v[46:49], a[188:191], v[50:53]
    s_nop 7
    v_mov_b32 v41, v50
    s_add_u32 m0, s4, 32768
    s_mov_b32 s69, 0x608000
    buffer_load_dwordx4 v20, s[36:39], s69 offen offset:0 sc1 lds
    buffer_load_dwordx4 v20, s[36:39], s69 offen offset:1024 sc1 lds
    buffer_load_dwordx4 v20, s[36:39], s69 offen offset:2048 sc1 lds
    buffer_load_dwordx4 v20, s[36:39], s69 offen offset:3072 sc1 lds
    s_waitcnt vmcnt(11)
    s_barrier
    ds_read_b64_tr_b16 v[138:139], v3 offset:0
    ds_read_b64_tr_b16 v[140:141], v3 offset:2048
    ds_read_b64_tr_b16 v[142:143], v4 offset:0
    ds_read_b64_tr_b16 v[144:145], v4 offset:2048
    ds_read_b64_tr_b16 v[146:147], v5 offset:0
    ds_read_b64_tr_b16 v[148:149], v5 offset:2048
    ds_read_b64_tr_b16 v[150:151], v6 offset:0
    ds_read_b64_tr_b16 v[152:153], v6 offset:2048
    s_waitcnt lgkmcnt(6)
    v_mfma_f32_16x16x32_bf16 v[84:87], v[138:141], v[138:141], 0
    s_waitcnt vmcnt(10)
    s_barrier
    ds_read_b64_tr_b16 v[154:155], v3 offset:4096
    s_nop 0
    s_add_u32 m0, s4, 49152
    v_mfma_f32_16x16x32_bf16 v[88:91], v[46:49], v[138:141], 0
    ds_read_b64_tr_b16 v[156:157], v3 offset:6144
    s_mov_b32 s69, 0x60c000
    v_mfma_f32_16x16x32_bf16 v[52:55], v[138:141], a[64:67], 0
    buffer_load_dwordx4 v20, s[36:39], s69 offen offset:0 sc1 lds
    v_mfma_f32_16x16x32_bf16 v[68:71], v[138:141], a[128:131], 0
    ds_read_b64_tr_b16 v[158:159], v4 offset:4096
    s_waitcnt lgkmcnt(7)
    v_mfma_f32_16x16x32_bf16 v[56:59], v[142:145], a[64:67], 0
    ds_read_b64_tr_b16 v[160:161], v4 offset:6144
    v_mfma_f32_16x16x32_bf16 v[72:75], v[142:145], a[128:131], 0
    buffer_load_dwordx4 v20, s[36:39], s69 offen offset:1024 sc1 lds
    s_waitcnt lgkmcnt(6)
    v_mfma_f32_16x16x32_bf16 v[60:63], v[146:149], a[64:67], 0
    ds_read_b64_tr_b16 v[162:163], v5 offset:4096
    v_mfma_f32_16x16x32_bf16 v[76:79], v[146:149], a[128:131], 0
    ds_read_b64_tr_b16 v[164:165], v5 offset:6144
    s_waitcnt lgkmcnt(6)
    v_mfma_f32_16x16x32_bf16 v[64:67], v[150:153], a[64:67], 0
    buffer_load_dwordx4 v20, s[36:39], s69 offen offset:2048 sc1 lds
    v_mfma_f32_16x16x32_bf16 v[80:83], v[150:153], a[128:131], 0
    ds_read_b64_tr_b16 v[166:167], v6 offset:4096
    s_waitcnt lgkmcnt(5)
    v_mfma_f32_16x16x32_bf16 v[84:87], v[154:157], v[154:157], v[84:87]
    ds_read_b64_tr_b16 v[168:169], v6 offset:6144
    v_mfma_f32_16x16x32_bf16 v[88:91], v[46:49], v[154:157], v[88:91]
    buffer_load_dwordx4 v20, s[36:39], s69 offen offset:3072 sc1 lds
    v_mfma_f32_16x16x32_bf16 v[52:55], v[154:157], a[68:71], v[52:55]
    s_waitcnt vmcnt(13)
    s_barrier
    ds_read_b64_tr_b16 v[170:171], v3 offset:8192
    v_mfma_f32_16x16x32_bf16 v[68:71], v[154:157], a[132:135], v[68:71]
    ds_read_b64_tr_b16 v[172:173], v3 offset:10240
    s_waitcnt lgkmcnt(6)
    v_mfma_f32_16x16x32_bf16 v[56:59], v[158:161], a[68:71], v[56:59]
    ds_read_b64_tr_b16 v[138:139], v4 offset:8192
    v_mfma_f32_16x16x32_bf16 v[72:75], v[158:161], a[132:135], v[72:75]
    ds_read_b64_tr_b16 v[140:141], v4 offset:10240
    s_waitcnt lgkmcnt(6)
    v_mfma_f32_16x16x32_bf16 v[60:63], v[162:165], a[68:71], v[60:63]
    ds_read_b64_tr_b16 v[142:143], v5 offset:8192
    v_mfma_f32_16x16x32_bf16 v[76:79], v[162:165], a[132:135], v[76:79]
    ds_read_b64_tr_b16 v[144:145], v5 offset:10240
    v_readfirstlane_b32 s54, v23
    s_waitcnt lgkmcnt(6)
    v_mfma_f32_16x16x32_bf16 v[64:67], v[166:169], a[68:71], v[64:67]
    ds_read_b64_tr_b16 v[146:147], v6 offset:8192
    v_and_b32_e64 v42, 48, v1
    v_mfma_f32_16x16x32_bf16 v[80:83], v[166:169], a[132:135], v[80:83]
    ds_read_b64_tr_b16 v[148:149], v6 offset:10240
    s_add_u32 s54, s54, 0x2d000
    s_waitcnt lgkmcnt(6)
    v_mfma_f32_16x16x32_bf16 v[84:87], v[170:173], v[170:173], v[84:87]
    buffer_load_dwordx4 v[42:45], v42, s[36:39], s54 offen sc1
    v_mfma_f32_16x16x32_bf16 v[88:91], v[46:49], v[170:173], v[88:91]
    s_waitcnt vmcnt(13)
    s_barrier
    ds_read_b64_tr_b16 v[150:151], v3 offset:12288
    v_mfma_f32_16x16x32_bf16 v[52:55], v[170:173], a[72:75], v[52:55]
    ds_read_b64_tr_b16 v[152:153], v3 offset:14336
    v_mfma_f32_16x16x32_bf16 v[68:71], v[170:173], a[136:139], v[68:71]
    ds_read_b64_tr_b16 v[154:155], v4 offset:12288
    s_waitcnt lgkmcnt(7)
    v_mfma_f32_16x16x32_bf16 v[56:59], v[138:141], a[72:75], v[56:59]
    ds_read_b64_tr_b16 v[156:157], v4 offset:14336
    v_mfma_f32_16x16x32_bf16 v[72:75], v[138:141], a[136:139], v[72:75]
    ds_read_b64_tr_b16 v[158:159], v5 offset:12288
    s_waitcnt lgkmcnt(7)
    v_mfma_f32_16x16x32_bf16 v[60:63], v[142:145], a[72:75], v[60:63]
    ds_read_b64_tr_b16 v[160:161], v5 offset:14336
    v_mfma_f32_16x16x32_bf16 v[76:79], v[142:145], a[136:139], v[76:79]
    ds_read_b64_tr_b16 v[162:163], v6 offset:12288
    s_waitcnt lgkmcnt(7)
    v_mfma_f32_16x16x32_bf16 v[64:67], v[146:149], a[72:75], v[64:67]
    ds_read_b64_tr_b16 v[164:165], v6 offset:14336
    v_mfma_f32_16x16x32_bf16 v[80:83], v[146:149], a[136:139], v[80:83]
    s_waitcnt vmcnt(9)
    s_barrier
    ds_read_b64_tr_b16 v[166:167], v3 offset:16384
    s_waitcnt lgkmcnt(7)
    v_mfma_f32_16x16x32_bf16 v[84:87], v[150:153], v[150:153], v[84:87]
    ds_read_b64_tr_b16 v[168:169], v3 offset:18432
    v_mfma_f32_16x16x32_bf16 v[88:91], v[46:49], v[150:153], v[88:91]
    ds_read_b64_tr_b16 v[170:171], v4 offset:16384
    v_mfma_f32_16x16x32_bf16 v[52:55], v[150:153], a[76:79], v[52:55]
    ds_read_b64_tr_b16 v[172:173], v4 offset:18432
    v_mfma_f32_16x16x32_bf16 v[68:71], v[150:153], a[140:143], v[68:71]
    ds_read_b64_tr_b16 v[138:139], v5 offset:16384
    s_mov_b32 s68, 0xe00000
    s_waitcnt lgkmcnt(9)
    v_mfma_f32_16x16x32_bf16 v[56:59], v[154:157], a[76:79], v[56:59]
    buffer_load_dwordx4 a[0:3], v38, s[36:39], s68 offen sc1
    v_mfma_f32_16x16x32_bf16 v[72:75], v[154:157], a[140:143], v[72:75]
    ds_read_b64_tr_b16 v[140:141], v5 offset:18432
    s_waitcnt lgkmcnt(8)
    v_mfma_f32_16x16x32_bf16 v[60:63], v[158:161], a[76:79], v[60:63]
    ds_read_b64_tr_b16 v[142:143], v6 offset:16384
    s_mov_b32 s68, 0xe08000
    v_mfma_f32_16x16x32_bf16 v[76:79], v[158:161], a[140:143], v[76:79]
    buffer_load_dwordx4 a[4:7], v38, s[36:39], s68 offen sc1
    s_waitcnt lgkmcnt(7)
    v_mfma_f32_16x16x32_bf16 v[64:67], v[162:165], a[76:79], v[64:67]
    ds_read_b64_tr_b16 v[144:145], v6 offset:18432
    v_mfma_f32_16x16x32_bf16 v[80:83], v[162:165], a[140:143], v[80:83]
    ds_read_b64_tr_b16 v[146:147], v3 offset:20480
    s_waitcnt lgkmcnt(7)
    v_mfma_f32_16x16x32_bf16 v[84:87], v[166:169], v[166:169], v[84:87]
    ds_read_b64_tr_b16 v[148:149], v3 offset:22528
    s_nop 0
    s_mov_b32 s68, 0xe10000
    v_mfma_f32_16x16x32_bf16 v[88:91], v[46:49], v[166:169], v[88:91]
    buffer_load_dwordx4 a[8:11], v38, s[36:39], s68 offen sc1
    v_mfma_f32_16x16x32_bf16 v[52:55], v[166:169], a[80:83], v[52:55]
    ds_read_b64_tr_b16 v[150:151], v4 offset:20480
    v_mfma_f32_16x16x32_bf16 v[68:71], v[166:169], a[144:147], v[68:71]
    ds_read_b64_tr_b16 v[152:153], v4 offset:22528
    s_waitcnt lgkmcnt(8)
    v_mfma_f32_16x16x32_bf16 v[56:59], v[170:173], a[80:83], v[56:59]
    ds_read_b64_tr_b16 v[154:155], v5 offset:20480
    s_mov_b32 s68, 0xe18000
    v_mfma_f32_16x16x32_bf16 v[72:75], v[170:173], a[144:147], v[72:75]
    buffer_load_dwordx4 a[12:15], v38, s[36:39], s68 offen sc1
    s_waitcnt lgkmcnt(7)
    v_mfma_f32_16x16x32_bf16 v[60:63], v[138:141], a[80:83], v[60:63]
    ds_read_b64_tr_b16 v[156:157], v5 offset:22528
    v_mfma_f32_16x16x32_bf16 v[76:79], v[138:141], a[144:147], v[76:79]
    ds_read_b64_tr_b16 v[158:159], v6 offset:20480
    s_mov_b32 s68, 0xe20000
    s_waitcnt lgkmcnt(7)
    v_mfma_f32_16x16x32_bf16 v[64:67], v[142:145], a[80:83], v[64:67]
    buffer_load_dwordx4 a[16:19], v38, s[36:39], s68 offen sc1
    v_mfma_f32_16x16x32_bf16 v[80:83], v[142:145], a[144:147], v[80:83]
    ds_read_b64_tr_b16 v[160:161], v6 offset:22528
    s_waitcnt lgkmcnt(6)
    v_mfma_f32_16x16x32_bf16 v[84:87], v[146:149], v[146:149], v[84:87]
    ds_read_b64_tr_b16 v[162:163], v3 offset:24576
    v_mfma_f32_16x16x32_bf16 v[88:91], v[46:49], v[146:149], v[88:91]
    ds_read_b64_tr_b16 v[164:165], v3 offset:26624
    s_mov_b32 s68, 0xe28000
    v_mfma_f32_16x16x32_bf16 v[52:55], v[146:149], a[84:87], v[52:55]
    buffer_load_dwordx4 a[20:23], v38, s[36:39], s68 offen sc1
    v_mfma_f32_16x16x32_bf16 v[68:71], v[146:149], a[148:151], v[68:71]
    ds_read_b64_tr_b16 v[166:167], v4 offset:24576
    s_waitcnt lgkmcnt(7)
    v_mfma_f32_16x16x32_bf16 v[56:59], v[150:153], a[84:87], v[56:59]
    ds_read_b64_tr_b16 v[168:169], v4 offset:26624
    v_mfma_f32_16x16x32_bf16 v[72:75], v[150:153], a[148:151], v[72:75]
    ds_read_b64_tr_b16 v[170:171], v5 offset:24576
    s_mov_b32 s68, 0xe30000
    s_waitcnt lgkmcnt(7)
    v_mfma_f32_16x16x32_bf16 v[60:63], v[154:157], a[84:87], v[60:63]
    buffer_load_dwordx4 a[24:27], v38, s[36:39], s68 offen sc1
    v_mfma_f32_16x16x32_bf16 v[76:79], v[154:157], a[148:151], v[76:79]
    ds_read_b64_tr_b16 v[172:173], v5 offset:26624
    s_waitcnt lgkmcnt(6)
    v_mfma_f32_16x16x32_bf16 v[64:67], v[158:161], a[84:87], v[64:67]
    ds_read_b64_tr_b16 v[138:139], v6 offset:24576
    v_mfma_f32_16x16x32_bf16 v[80:83], v[158:161], a[148:151], v[80:83]
    ds_read_b64_tr_b16 v[140:141], v6 offset:26624
    s_mov_b32 s68, 0xe38000
    s_waitcnt lgkmcnt(6)
    v_mfma_f32_16x16x32_bf16 v[84:87], v[162:165], v[162:165], v[84:87]
    buffer_load_dwordx4 a[28:31], v38, s[36:39], s68 offen sc1
    v_mfma_f32_16x16x32_bf16 v[88:91], v[46:49], v[162:165], v[88:91]
    ds_read_b64_tr_b16 v[142:143], v3 offset:28672
    v_mfma_f32_16x16x32_bf16 v[52:55], v[162:165], a[88:91], v[52:55]
    ds_read_b64_tr_b16 v[144:145], v3 offset:30720
    s_mov_b32 s68, 0xe40000
    v_mfma_f32_16x16x32_bf16 v[68:71], v[162:165], a[152:155], v[68:71]
    buffer_load_dwordx4 a[32:35], v38, s[36:39], s68 offen sc1
    s_waitcnt lgkmcnt(6)
    v_mfma_f32_16x16x32_bf16 v[56:59], v[166:169], a[88:91], v[56:59]
    ds_read_b64_tr_b16 v[146:147], v4 offset:28672
    v_mfma_f32_16x16x32_bf16 v[72:75], v[166:169], a[152:155], v[72:75]
    ds_read_b64_tr_b16 v[148:149], v4 offset:30720
    s_waitcnt lgkmcnt(6)
    v_mfma_f32_16x16x32_bf16 v[60:63], v[170:173], a[88:91], v[60:63]
    ds_read_b64_tr_b16 v[150:151], v5 offset:28672
    s_mov_b32 s68, 0xe48000
    v_mfma_f32_16x16x32_bf16 v[76:79], v[170:173], a[152:155], v[76:79]
    buffer_load_dwordx4 a[36:39], v38, s[36:39], s68 offen sc1
    s_waitcnt lgkmcnt(5)
    v_mfma_f32_16x16x32_bf16 v[64:67], v[138:141], a[88:91], v[64:67]
    ds_read_b64_tr_b16 v[152:153], v5 offset:30720
    v_mfma_f32_16x16x32_bf16 v[80:83], v[138:141], a[152:155], v[80:83]
    ds_read_b64_tr_b16 v[154:155], v6 offset:28672
    s_waitcnt lgkmcnt(5)
    v_mfma_f32_16x16x32_bf16 v[84:87], v[142:145], v[142:145], v[84:87]
    ds_read_b64_tr_b16 v[156:157], v6 offset:30720
    s_mov_b32 s68, 0xe50000
    v_mfma_f32_16x16x32_bf16 v[88:91], v[46:49], v[142:145], v[88:91]
    buffer_load_dwordx4 a[40:43], v38, s[36:39], s68 offen sc1
    v_mfma_f32_16x16x32_bf16 v[52:55], v[142:145], a[92:95], v[52:55]
    s_waitcnt vmcnt(16)
    s_barrier
    ds_read_b64_tr_b16 v[158:159], v3 offset:32768
    v_mfma_f32_16x16x32_bf16 v[68:71], v[142:145], a[156:159], v[68:71]
    ds_read_b64_tr_b16 v[160:161], v3 offset:34816
    s_waitcnt lgkmcnt(6)
    v_mfma_f32_16x16x32_bf16 v[56:59], v[146:149], a[92:95], v[56:59]
    ds_read_b64_tr_b16 v[162:163], v4 offset:32768
    s_mov_b32 s68, 0xe58000
    v_mfma_f32_16x16x32_bf16 v[72:75], v[146:149], a[156:159], v[72:75]
    buffer_load_dwordx4 a[44:47], v38, s[36:39], s68 offen sc1
    s_waitcnt lgkmcnt(5)
    v_mfma_f32_16x16x32_bf16 v[60:63], v[150:153], a[92:95], v[60:63]
    ds_read_b64_tr_b16 v[164:165], v4 offset:34816
    v_mfma_f32_16x16x32_bf16 v[76:79], v[150:153], a[156:159], v[76:79]
    ds_read_b64_tr_b16 v[166:167], v5 offset:32768
    s_mov_b32 s68, 0xe60000
    s_waitcnt lgkmcnt(5)
    v_mfma_f32_16x16x32_bf16 v[64:67], v[154:157], a[92:95], v[64:67]
    buffer_load_dwordx4 a[48:51], v38, s[36:39], s68 offen sc1
    v_mfma_f32_16x16x32_bf16 v[80:83], v[154:157], a[156:159], v[80:83]
    ds_read_b64_tr_b16 v[168:169], v5 offset:34816
    s_waitcnt lgkmcnt(4)
    v_mfma_f32_16x16x32_bf16 v[84:87], v[158:161], v[158:161], v[84:87]
    ds_read_b64_tr_b16 v[170:171], v6 offset:32768
    v_mfma_f32_16x16x32_bf16 v[88:91], v[46:49], v[158:161], v[88:91]
    ds_read_b64_tr_b16 v[172:173], v6 offset:34816
    s_mov_b32 s68, 0xe68000
    v_mfma_f32_16x16x32_bf16 v[52:55], v[158:161], a[96:99], v[52:55]
    buffer_load_dwordx4 a[52:55], v38, s[36:39], s68 offen sc1
    v_mfma_f32_16x16x32_bf16 v[68:71], v[158:161], a[160:163], v[68:71]
    ds_read_b64_tr_b16 v[138:139], v3 offset:36864
    s_waitcnt lgkmcnt(5)
    v_mfma_f32_16x16x32_bf16 v[56:59], v[162:165], a[96:99], v[56:59]
    ds_read_b64_tr_b16 v[140:141], v3 offset:38912
    v_mfma_f32_16x16x32_bf16 v[72:75], v[162:165], a[160:163], v[72:75]
    ds_read_b64_tr_b16 v[142:143], v4 offset:36864
    s_mov_b32 s68, 0xe70000
    s_waitcnt lgkmcnt(5)
    v_mfma_f32_16x16x32_bf16 v[60:63], v[166:169], a[96:99], v[60:63]
    buffer_load_dwordx4 a[56:59], v38, s[36:39], s68 offen sc1
    v_mfma_f32_16x16x32_bf16 v[76:79], v[166:169], a[160:163], v[76:79]
    ds_read_b64_tr_b16 v[144:145], v4 offset:38912
    s_waitcnt lgkmcnt(4)
    v_mfma_f32_16x16x32_bf16 v[64:67], v[170:173], a[96:99], v[64:67]
    ds_read_b64_tr_b16 v[146:147], v5 offset:36864
    v_mfma_f32_16x16x32_bf16 v[80:83], v[170:173], a[160:163], v[80:83]
    ds_read_b64_tr_b16 v[148:149], v5 offset:38912
    s_mov_b32 s68, 0xe78000
    s_waitcnt lgkmcnt(4)
    v_mfma_f32_16x16x32_bf16 v[84:87], v[138:141], v[138:141], v[84:87]
    buffer_load_dwordx4 a[60:63], v38, s[36:39], s68 offen sc1
    v_mfma_f32_16x16x32_bf16 v[88:91], v[46:49], v[138:141], v[88:91]
    ds_read_b64_tr_b16 v[150:151], v6 offset:36864
    v_mfma_f32_16x16x32_bf16 v[52:55], v[138:141], a[100:103], v[52:55]
    ds_read_b64_tr_b16 v[152:153], v6 offset:38912
    s_xor_b32 s68, s0, 0xe80000
    v_mfma_f32_16x16x32_bf16 v[68:71], v[138:141], a[164:167], v[68:71]
    buffer_load_dwordx4 a[192:195], v39, s[36:39], s68 offen sc1
    s_waitcnt lgkmcnt(4)
    v_mfma_f32_16x16x32_bf16 v[56:59], v[142:145], a[100:103], v[56:59]
    ds_read_b64_tr_b16 v[154:155], v3 offset:40960
    v_mfma_f32_16x16x32_bf16 v[72:75], v[142:145], a[164:167], v[72:75]
    ds_read_b64_tr_b16 v[156:157], v3 offset:43008
    s_waitcnt lgkmcnt(4)
    v_mfma_f32_16x16x32_bf16 v[60:63], v[146:149], a[100:103], v[60:63]
    ds_read_b64_tr_b16 v[158:159], v4 offset:40960
    s_xor_b32 s68, s0, 0xe84000
    v_mfma_f32_16x16x32_bf16 v[76:79], v[146:149], a[164:167], v[76:79]
    buffer_load_dwordx4 a[196:199], v39, s[36:39], s68 offen sc1
    s_waitcnt lgkmcnt(3)
    v_mfma_f32_16x16x32_bf16 v[64:67], v[150:153], a[100:103], v[64:67]
    ds_read_b64_tr_b16 v[160:161], v4 offset:43008
    v_mfma_f32_16x16x32_bf16 v[80:83], v[150:153], a[164:167], v[80:83]
    ds_read_b64_tr_b16 v[162:163], v5 offset:40960
    s_waitcnt lgkmcnt(3)
    v_mfma_f32_16x16x32_bf16 v[84:87], v[154:157], v[154:157], v[84:87]
    ds_read_b64_tr_b16 v[164:165], v5 offset:43008
    s_xor_b32 s68, s0, 0xea0000
    v_mfma_f32_16x16x32_bf16 v[88:91], v[46:49], v[154:157], v[88:91]
    buffer_load_dwordx4 a[224:227], v39, s[36:39], s68 offen sc1
    v_mfma_f32_16x16x32_bf16 v[52:55], v[154:157], a[104:107], v[52:55]
    ds_read_b64_tr_b16 v[166:167], v6 offset:40960
    v_mfma_f32_16x16x32_bf16 v[68:71], v[154:157], a[168:171], v[68:71]
    ds_read_b64_tr_b16 v[168:169], v6 offset:43008
    s_xor_b32 s68, s0, 0xea4000
    s_waitcnt lgkmcnt(4)
    v_mfma_f32_16x16x32_bf16 v[56:59], v[158:161], a[104:107], v[56:59]
    buffer_load_dwordx4 a[228:231], v39, s[36:39], s68 offen sc1
    v_mfma_f32_16x16x32_bf16 v[72:75], v[158:161], a[168:171], v[72:75]
    ds_read_b64_tr_b16 v[170:171], v3 offset:45056
    s_waitcnt lgkmcnt(3)
    v_mfma_f32_16x16x32_bf16 v[60:63], v[162:165], a[104:107], v[60:63]
    ds_read_b64_tr_b16 v[172:173], v3 offset:47104
    v_mfma_f32_16x16x32_bf16 v[76:79], v[162:165], a[168:171], v[76:79]
    ds_read_b64_tr_b16 v[138:139], v4 offset:45056
    s_xor_b32 s68, s0, 0xec0000
    s_waitcnt lgkmcnt(3)
    v_mfma_f32_16x16x32_bf16 v[64:67], v[166:169], a[104:107], v[64:67]
    buffer_load_dwordx4 v[192:195], v39, s[36:39], s68 offen sc1
    v_mfma_f32_16x16x32_bf16 v[80:83], v[166:169], a[168:171], v[80:83]
    ds_read_b64_tr_b16 v[140:141], v4 offset:47104
    s_waitcnt lgkmcnt(2)
    v_mfma_f32_16x16x32_bf16 v[84:87], v[170:173], v[170:173], v[84:87]
    ds_read_b64_tr_b16 v[142:143], v5 offset:45056
    v_mfma_f32_16x16x32_bf16 v[88:91], v[46:49], v[170:173], v[88:91]
    ds_read_b64_tr_b16 v[144:145], v5 offset:47104
    s_xor_b32 s68, s0, 0xec4000
    v_mfma_f32_16x16x32_bf16 v[52:55], v[170:173], a[108:111], v[52:55]
    buffer_load_dwordx4 v[196:199], v39, s[36:39], s68 offen sc1
    v_mfma_f32_16x16x32_bf16 v[68:71], v[170:173], a[172:175], v[68:71]
    ds_read_b64_tr_b16 v[146:147], v6 offset:45056
    s_waitcnt lgkmcnt(3)
    v_mfma_f32_16x16x32_bf16 v[56:59], v[138:141], a[108:111], v[56:59]
    ds_read_b64_tr_b16 v[148:149], v6 offset:47104
    v_mfma_f32_16x16x32_bf16 v[72:75], v[138:141], a[172:175], v[72:75]
    s_waitcnt vmcnt(23)
    s_barrier
    s_cmp_lg_u32 s67, 1
    s_cbranch_scc1 L_nofbx0
    s_mov_b32 s53, 0x2c000
    v_mov_b32 v34, 1
    s_mov_b64 exec, 1
    buffer_atomic_add v34, v32, s[36:39], s53 offen
    s_mov_b64 exec, -1
L_nofbx0:
    ds_read_b64_tr_b16 v[150:151], v3 offset:49152
    s_xor_b32 s68, s0, 0xee0000
    s_waitcnt lgkmcnt(3)
    v_mfma_f32_16x16x32_bf16 v[60:63], v[142:145], a[108:111], v[60:63]
    buffer_load_dwordx4 v[224:227], v39, s[36:39], s68 offen sc1
    v_mfma_f32_16x16x32_bf16 v[76:79], v[142:145], a[172:175], v[76:79]
    ds_read_b64_tr_b16 v[152:153], v3 offset:51200
    s_waitcnt lgkmcnt(2)
    v_mfma_f32_16x16x32_bf16 v[64:67], v[146:149], a[108:111], v[64:67]
    ds_read_b64_tr_b16 v[154:155], v3 offset:53248
    s_xor_b32 s68, s0, 0xee4000
    v_mfma_f32_16x16x32_bf16 v[80:83], v[146:149], a[172:175], v[80:83]
    buffer_load_dwordx4 v[228:231], v39, s[36:39], s68 offen sc1
    s_waitcnt lgkmcnt(1)
    v_mfma_f32_16x16x32_bf16 v[84:87], v[150:153], v[150:153], v[84:87]
    ds_read_b64_tr_b16 v[156:157], v3 offset:55296
    v_mfma_f32_16x16x32_bf16 v[88:91], v[46:49], v[150:153], v[88:91]
    ds_read_b64_tr_b16 v[158:159], v3 offset:57344
    v_mfma_f32_16x16x32_bf16 v[52:55], v[150:153], a[112:115], v[52:55]
    ds_read_b64_tr_b16 v[160:161], v3 offset:59392
    s_xor_b32 s68, s0, 0xe88000
    v_mfma_f32_16x16x32_bf16 v[68:71], v[150:153], a[176:179], v[68:71]
    buffer_load_dwordx4 a[200:203], v39, s[36:39], s68 offen sc1
    s_waitcnt lgkmcnt(2)
    v_mfma_f32_16x16x32_bf16 v[84:87], v[154:157], v[154:157], v[84:87]
    ds_read_b64_tr_b16 v[162:163], v3 offset:61440
    v_mfma_f32_16x16x32_bf16 v[88:91], v[46:49], v[154:157], v[88:91]
    ds_read_b64_tr_b16 v[164:165], v3 offset:63488
    v_mfma_f32_16x16x32_bf16 v[52:55], v[154:157], a[116:119], v[52:55]
    ds_read_b64_tr_b16 v[166:167], v4 offset:49152
    s_xor_b32 s68, s0, 0xe8c000
    v_mfma_f32_16x16x32_bf16 v[68:71], v[154:157], a[180:183], v[68:71]
    buffer_load_dwordx4 a[204:207], v39, s[36:39], s68 offen sc1
    s_waitcnt lgkmcnt(3)
    v_mfma_f32_16x16x32_bf16 v[84:87], v[158:161], v[158:161], v[84:87]
    ds_read_b64_tr_b16 v[168:169], v4 offset:51200
    v_mfma_f32_16x16x32_bf16 v[88:91], v[46:49], v[158:161], v[88:91]
    ds_read_b64_tr_b16 v[170:171], v4 offset:53248
    v_xor_b32 v132, 64, v31
    v_mfma_f32_16x16x32_bf16 v[52:55], v[158:161], a[120:123], v[52:55]
    ds_read_b64_tr_b16 v[172:173], v4 offset:55296
    v_xor_b32_e64 v133, 64, v30
    s_xor_b32 s68, s0, 0xea8000
    v_mfma_f32_16x16x32_bf16 v[68:71], v[158:161], a[184:187], v[68:71]
    v_xor_b32 v134, 128, v31
    buffer_load_dwordx4 a[232:235], v39, s[36:39], s68 offen sc1
    s_waitcnt lgkmcnt(4)
    v_mfma_f32_16x16x32_bf16 v[84:87], v[162:165], v[162:165], v[84:87]
    ds_read_b64_tr_b16 v[138:139], v4 offset:57344
    s_nop 0
    v_xor_b32 v135, 128, v30
    v_mfma_f32_16x16x32_bf16 v[88:91], v[46:49], v[162:165], v[88:91]
    ds_read_b64_tr_b16 v[140:141], v4 offset:59392
    v_xor_b32 v136, 192, v31
    s_xor_b32 s68, s0, 0xeac000
    v_mfma_f32_16x16x32_bf16 v[52:55], v[162:165], a[124:127], v[52:55]
    v_xor_b32 v137, 192, v30
    buffer_load_dwordx4 a[236:239], v39, s[36:39], s68 offen sc1
    v_mfma_f32_16x16x32_bf16 v[68:71], v[162:165], a[188:191], v[68:71]
    ds_read_b64_tr_b16 v[142:143], v4 offset:61440
    s_waitcnt lgkmcnt(5)
    v_mfma_f32_16x16x32_bf16 v[56:59], v[166:169], a[112:115], v[56:59]
    ds_read_b64_tr_b16 v[144:145], v4 offset:63488
    v_mfma_f32_16x16x32_bf16 v[72:75], v[166:169], a[176:179], v[72:75]
    ds_read_b64_tr_b16 v[146:147], v5 offset:49152
    v_cndmask_b32 v84, v84, v85, s[22:23]
    v_cndmask_b32 v86, v86, v87, s[22:23]
    s_xor_b32 s68, s0, 0xec8000
    s_waitcnt lgkmcnt(5)
    v_mfma_f32_16x16x32_bf16 v[56:59], v[170:173], a[116:119], v[56:59]
    v_mul_f32_e64 v88, s62, v88
    buffer_load_dwordx4 v[200:203], v39, s[36:39], s68 offen sc1
    v_mfma_f32_16x16x32_bf16 v[72:75], v[170:173], a[180:183], v[72:75]
    ds_read_b64_tr_b16 v[148:149], v5 offset:51200
    v_cndmask_b32 v84, v84, v86, s[34:35]
    v_mul_f32 v85, v88, v88
    s_waitcnt lgkmcnt(4)
    v_mfma_f32_16x16x32_bf16 v[56:59], v[138:141], a[120:123], v[56:59]
    ds_read_b64_tr_b16 v[150:151], v5 offset:53248
    v_fma_f32 v85, v84, s62, -v85
    v_cvt_pk_bf16_f32 v88, v88, v88
    v_mfma_f32_16x16x32_bf16 v[72:75], v[138:141], a[184:187], v[72:75]
    ds_read_b64_tr_b16 v[152:153], v5 offset:55296
    v_max_f32 v85, 0, v85
    v_add_f32 v85, s63, v85
    s_xor_b32 s68, s0, 0xecc000
    s_waitcnt lgkmcnt(4)
    v_mfma_f32_16x16x32_bf16 v[56:59], v[142:145], a[124:127], v[56:59]
    v_rsq_f32 v85, v85
    v_and_b32 v88, 0xffff0000, v88
    buffer_load_dwordx4 v[204:207], v39, s[36:39], s68 offen sc1
    v_mfma_f32_16x16x32_bf16 v[72:75], v[142:145], a[188:191], v[72:75]
    ds_read_b64_tr_b16 v[154:155], v5 offset:57344
    v_mul_f32 v84, v88, v85
    s_waitcnt lgkmcnt(3)
    v_mfma_f32_16x16x32_bf16 v[60:63], v[146:149], a[112:115], v[60:63]
    s_mov_b32 exec_lo, 0x00f0000f
    s_mov_b32 exec_hi, 0xf0000f00
    ds_write2st64_b32 v30, v85, v84 offset0:0 offset1:1
    s_mov_b64 exec, -1
    v_mfma_f32_16x16x32_bf16 v[76:79], v[146:149], a[176:179], v[76:79]
    ds_read_b64_tr_b16 v[156:157], v5 offset:59392
    s_waitcnt lgkmcnt(3)
    v_mfma_f32_16x16x32_bf16 v[60:63], v[150:153], a[116:119], v[60:63]
    ds_read_b64_tr_b16 v[158:159], v5 offset:61440
    v_mfma_f32_16x16x32_bf16 v[76:79], v[150:153], a[180:183], v[76:79]
    ds_read_b64_tr_b16 v[160:161], v5 offset:63488
    s_waitcnt lgkmcnt(3)
    s_barrier
    s_waitcnt lgkmcnt(2)
    v_mfma_f32_16x16x32_bf16 v[60:63], v[154:157], a[120:123], v[60:63]
    ds_read_b64_tr_b16 v[162:163], v6 offset:49152
    ds_read_b128 v[96:99], v31 offset:256
    v_mfma_f32_16x16x32_bf16 v[76:79], v[154:157], a[184:187], v[76:79]
    ds_read_b64_tr_b16 v[164:165], v6 offset:51200
    ds_read_b128 v[92:95], v31
    s_waitcnt lgkmcnt(4)
    v_mfma_f32_16x16x32_bf16 v[60:63], v[158:161], a[124:127], v[60:63]
    ds_read_b64_tr_b16 v[166:167], v6 offset:53248
    ds_read_b128 v[104:107], v132 offset:256
    v_mfma_f32_16x16x32_bf16 v[76:79], v[158:161], a[188:191], v[76:79]
    ds_read_b64_tr_b16 v[168:169], v6 offset:55296
    ds_read_b128 v[100:103], v132
    s_waitcnt lgkmcnt(5)
    v_mfma_f32_16x16x32_bf16 v[64:67], v[162:165], a[112:115], v[64:67]
    ds_read_b64_tr_b16 v[170:171], v6 offset:57344
    ds_read_b128 v[112:115], v134 offset:256
    v_mfma_f32_16x16x32_bf16 v[80:83], v[162:165], a[176:179], v[80:83]
    ds_read_b64_tr_b16 v[172:173], v6 offset:59392
    ds_read_b128 v[108:111], v134
    s_waitcnt lgkmcnt(5)
    v_mfma_f32_16x16x32_bf16 v[64:67], v[166:169], a[116:119], v[64:67]
    ds_read_b64_tr_b16 v[138:139], v6 offset:61440
    ds_read_b128 v[120:123], v136 offset:256
    v_mfma_f32_16x16x32_bf16 v[80:83], v[166:169], a[180:183], v[80:83]
    ds_read_b64_tr_b16 v[140:141], v6 offset:63488
    ds_read_b128 v[116:119], v136
    s_waitcnt lgkmcnt(5)
    v_mfma_f32_16x16x32_bf16 v[64:67], v[170:173], a[120:123], v[64:67]
    ds_read2st64_b32 v[124:125], v30 offset0:0 offset1:1
    v_mfma_f32_16x16x32_bf16 v[80:83], v[170:173], a[184:187], v[80:83]
    ds_read2st64_b32 v[126:127], v133 offset0:0 offset1:1
    s_waitcnt lgkmcnt(3)
    v_mfma_f32_16x16x32_bf16 v[64:67], v[138:141], a[124:127], v[64:67]
    ds_read2st64_b32 v[128:129], v135 offset0:0 offset1:1
    v_mfma_f32_16x16x32_bf16 v[80:83], v[138:141], a[188:191], v[80:83]
    ds_read2st64_b32 v[130:131], v137 offset0:0 offset1:1
    v_pk_fma_f32 v[84:85], v[96:97], v[40:41], s[66:67] op_sel:[0,0,0] op_sel_hi:[1,0,0] neg_lo:[1,0,0] neg_hi:[1,0,0]
    v_pk_fma_f32 v[86:87], v[98:99], v[40:41], s[66:67] op_sel:[0,0,0] op_sel_hi:[1,0,0] neg_lo:[1,0,0] neg_hi:[1,0,0]
    v_pk_fma_f32 v[52:53], v[52:53], v[92:93], v[84:85] op_sel:[0,0,0] op_sel_hi:[1,1,1]
    v_pk_fma_f32 v[54:55], v[54:55], v[94:95], v[86:87] op_sel:[0,0,0] op_sel_hi:[1,1,1]
    v_pk_mul_f32 v[68:69], v[68:69], v[92:93] op_sel:[0,0] op_sel_hi:[1,1]
    v_pk_mul_f32 v[70:71], v[70:71], v[94:95] op_sel:[0,0] op_sel_hi:[1,1]
    v_pk_fma_f32 v[68:69], v[96:97], v[40:41], v[68:69] op_sel:[0,1,0] op_sel_hi:[1,1,1] neg_lo:[1,0,0] neg_hi:[1,0,0]
    v_pk_fma_f32 v[70:71], v[98:99], v[40:41], v[70:71] op_sel:[0,1,0] op_sel_hi:[1,1,1] neg_lo:[1,0,0] neg_hi:[1,0,0]
    v_pk_fma_f32 v[84:85], v[52:53], s[64:65], s[64:65] op_sel:[0,0,1] op_sel_hi:[1,0,1]
    v_pk_fma_f32 v[86:87], v[54:55], s[64:65], s[64:65] op_sel:[0,0,1] op_sel_hi:[1,0,1]
    v_exp_f32_e64 v84, v84 clamp
    v_exp_f32_e64 v85, v85 clamp
    v_exp_f32_e64 v86, v86 clamp
    v_exp_f32_e64 v87, v87 clamp
    v_max_f32 v52, s66, v52
    v_max_f32 v53, s66, v53
    v_max_f32 v54, s66, v54
    v_max_f32 v55, s66, v55
    v_pk_add_f32 v[52:53], v[52:53], v[84:85] op_sel:[0,0] op_sel_hi:[1,1]
    v_pk_add_f32 v[54:55], v[54:55], v[86:87] op_sel:[0,0] op_sel_hi:[1,1]
    v_cvt_pk_bf16_f32 v140, v68, v69
    v_cvt_pk_bf16_f32 v141, v70, v71
L_stub_s2_0:
    s_cbranch_execz L_tback_s2
    s_nop 0
    v_cvt_pk_bf16_f32 v132, v52, v53
    v_cvt_pk_bf16_f32 v133, v54, v55
    v_pk_fma_f32 v[84:85], v[104:105], v[40:41], s[66:67] op_sel:[0,0,0] op_sel_hi:[1,0,0] neg_lo:[1,0,0] neg_hi:[1,0,0]
    v_pk_fma_f32 v[86:87], v[106:107], v[40:41], s[66:67] op_sel:[0,0,0] op_sel_hi:[1,0,0] neg_lo:[1,0,0] neg_hi:[1,0,0]
    v_pk_fma_f32 v[56:57], v[56:57], v[100:101], v[84:85] op_sel:[0,0,0] op_sel_hi:[1,1,1]
    v_pk_fma_f32 v[58:59], v[58:59], v[102:103], v[86:87] op_sel:[0,0,0] op_sel_hi:[1,1,1]
    v_pk_mul_f32 v[72:73], v[72:73], v[100:101] op_sel:[0,0] op_sel_hi:[1,1]
    v_pk_mul_f32 v[74:75], v[74:75], v[102:103] op_sel:[0,0] op_sel_hi:[1,1]
    v_pk_fma_f32 v[72:73], v[104:105], v[40:41], v[72:73] op_sel:[0,1,0] op_sel_hi:[1,1,1] neg_lo:[1,0,0] neg_hi:[1,0,0]
    v_pk_fma_f32 v[74:75], v[106:107], v[40:41], v[74:75] op_sel:[0,1,0] op_sel_hi:[1,1,1] neg_lo:[1,0,0] neg_hi:[1,0,0]
    v_pk_fma_f32 v[84:85], v[56:57], s[64:65], s[64:65] op_sel:[0,0,1] op_sel_hi:[1,0,1]
    v_pk_fma_f32 v[86:87], v[58:59], s[64:65], s[64:65] op_sel:[0,0,1] op_sel_hi:[1,0,1]
    v_exp_f32_e64 v84, v84 clamp
    v_exp_f32_e64 v85, v85 clamp
    v_exp_f32_e64 v86, v86 clamp
    v_exp_f32_e64 v87, v87 clamp
    v_max_f32 v56, s66, v56
    v_max_f32 v57, s66, v57
    v_max_f32 v58, s66, v58
    v_max_f32 v59, s66, v59
    v_pk_add_f32 v[56:57], v[56:57], v[84:85] op_sel:[0,0] op_sel_hi:[1,1]
    v_pk_add_f32 v[58:59], v[58:59], v[86:87] op_sel:[0,0] op_sel_hi:[1,1]
    v_cvt_pk_bf16_f32 v142, v72, v73
    v_cvt_pk_bf16_f32 v143, v74, v75
    v_cvt_pk_bf16_f32 v134, v56, v57
    v_cvt_pk_bf16_f32 v135, v58, v59
    v_pk_fma_f32 v[84:85], v[112:113], v[40:41], s[66:67] op_sel:[0,0,0] op_sel_hi:[1,0,0] neg_lo:[1,0,0] neg_hi:[1,0,0]
    v_pk_fma_f32 v[86:87], v[114:115], v[40:41], s[66:67] op_sel:[0,0,0] op_sel_hi:[1,0,0] neg_lo:[1,0,0] neg_hi:[1,0,0]
    v_pk_fma_f32 v[60:61], v[60:61], v[108:109], v[84:85] op_sel:[0,0,0] op_sel_hi:[1,1,1]
    v_pk_fma_f32 v[62:63], v[62:63], v[110:111], v[86:87] op_sel:[0,0,0] op_sel_hi:[1,1,1]
    v_pk_mul_f32 v[76:77], v[76:77], v[108:109] op_sel:[0,0] op_sel_hi:[1,1]
    v_pk_mul_f32 v[78:79], v[78:79], v[110:111] op_sel:[0,0] op_sel_hi:[1,1]
    v_pk_fma_f32 v[76:77], v[112:113], v[40:41], v[76:77] op_sel:[0,1,0] op_sel_hi:[1,1,1] neg_lo:[1,0,0] neg_hi:[1,0,0]
    v_pk_fma_f32 v[78:79], v[114:115], v[40:41], v[78:79] op_sel:[0,1,0] op_sel_hi:[1,1,1] neg_lo:[1,0,0] neg_hi:[1,0,0]
    v_pk_fma_f32 v[84:85], v[60:61], s[64:65], s[64:65] op_sel:[0,0,1] op_sel_hi:[1,0,1]
    v_pk_fma_f32 v[86:87], v[62:63], s[64:65], s[64:65] op_sel:[0,0,1] op_sel_hi:[1,0,1]
    v_mfma_f32_16x16x32_bf16 v[88:91], v[140:143], v[132:135], 0
    v_exp_f32_e64 v84, v84 clamp
    v_exp_f32_e64 v85, v85 clamp
    v_mfma_f32_16x16x32_bf16 v[148:151], v[46:49], v[132:135], 0
    v_exp_f32_e64 v86, v86 clamp
    v_exp_f32_e64 v87, v87 clamp
    v_max_f32 v60, s66, v60
    v_max_f32 v61, s66, v61
    v_max_f32 v62, s66, v62
    v_max_f32 v63, s66, v63
    v_pk_add_f32 v[60:61], v[60:61], v[84:85] op_sel:[0,0] op_sel_hi:[1,1]
    v_pk_add_f32 v[62:63], v[62:63], v[86:87] op_sel:[0,0] op_sel_hi:[1,1]
    v_cvt_pk_bf16_f32 v144, v76, v77
    v_cvt_pk_bf16_f32 v145, v78, v79
    v_cvt_pk_bf16_f32 v136, v60, v61
    v_cvt_pk_bf16_f32 v137, v62, v63
    v_pk_fma_f32 v[84:85], v[120:121], v[40:41], s[66:67] op_sel:[0,0,0] op_sel_hi:[1,0,0] neg_lo:[1,0,0] neg_hi:[1,0,0]
    v_pk_fma_f32 v[86:87], v[122:123], v[40:41], s[66:67] op_sel:[0,0,0] op_sel_hi:[1,0,0] neg_lo:[1,0,0] neg_hi:[1,0,0]
    s_waitcnt lgkmcnt(4)
    s_nop 0
    v_pk_fma_f32 v[64:65], v[64:65], v[116:117], v[84:85] op_sel:[0,0,0] op_sel_hi:[1,1,1]
    v_pk_fma_f32 v[66:67], v[66:67], v[118:119], v[86:87] op_sel:[0,0,0] op_sel_hi:[1,1,1]
    v_pk_mul_f32 v[80:81], v[80:81], v[116:117] op_sel:[0,0] op_sel_hi:[1,1]
    v_pk_mul_f32 v[82:83], v[82:83], v[118:119] op_sel:[0,0] op_sel_hi:[1,1]
    v_pk_fma_f32 v[80:81], v[120:121], v[40:41], v[80:81] op_sel:[0,1,0] op_sel_hi:[1,1,1] neg_lo:[1,0,0] neg_hi:[1,0,0]
    v_pk_fma_f32 v[82:83], v[122:123], v[40:41], v[82:83] op_sel:[0,1,0] op_sel_hi:[1,1,1] neg_lo:[1,0,0] neg_hi:[1,0,0]
    v_pk_fma_f32 v[84:85], v[64:65], s[64:65], s[64:65] op_sel:[0,0,1] op_sel_hi:[1,0,1]
    v_pk_fma_f32 v[86:87], v[66:67], s[64:65], s[64:65] op_sel:[0,0,1] op_sel_hi:[1,0,1]
    v_exp_f32_e64 v84, v84 clamp
    v_exp_f32_e64 v85, v85 clamp
    v_exp_f32_e64 v86, v86 clamp
    v_exp_f32_e64 v87, v87 clamp
    v_max_f32 v64, s66, v64
    v_max_f32 v65, s66, v65
    v_max_f32 v66, s66, v66
    v_max_f32 v67, s66, v67
    v_pk_add_f32 v[64:65], v[64:65], v[84:85] op_sel:[0,0] op_sel_hi:[1,1]
    v_pk_add_f32 v[66:67], v[66:67], v[86:87] op_sel:[0,0] op_sel_hi:[1,1]
    v_cvt_pk_bf16_f32 v146, v80, v81
    v_cvt_pk_bf16_f32 v147, v82, v83
    v_cvt_pk_bf16_f32 v138, v64, v65
    v_cvt_pk_bf16_f32 v139, v66, v67
    s_waitcnt lgkmcnt(2)
    v_cmp_u_f32 vcc, v125, v127
    s_waitcnt lgkmcnt(0)
    v_cmp_u_f32 s[68:69], v129, v131
    s_nop 0
    s_or_b64 vcc, vcc, s[68:69]
    s_cbranch_scc1 L_slowx0
L_okx0:
    s_mov_b32 s55, 0x10000
    s_mov_b32 s53, 0x18000
    v_mfma_f32_16x16x32_bf16 v[88:91], v[144:147], v[136:139], v[88:91]
    v_mfma_f32_16x16x32_bf16 v[148:151], v[46:49], v[136:139], v[148:151]
    ds_read_b64_tr_b16 v[74:75], v3 offset:0
    ds_read_b64_tr_b16 v[76:77], v3 offset:2048
    ds_read_b64_tr_b16 v[78:79], v4 offset:0
    ds_read_b64_tr_b16 v[80:81], v4 offset:2048
    s_nop 2
    s_nop 0
    buffer_atomic_add_f32 v88, v22, s[36:39], s55 offen offset:0
    buffer_atomic_add_f32 v89, v22, s[36:39], s55 offen offset:128
    buffer_atomic_add_f32 v90, v22, s[36:39], s55 offen offset:256
    buffer_atomic_add_f32 v91, v22, s[36:39], s55 offen offset:384
    s_mov_b64 exec, 0xffff
    buffer_atomic_add_f32 v148, v23, s[36:39], s53 offen
    s_mov_b64 exec, -1
    ds_read_b64_tr_b16 v[92:93], v5 offset:0
    ds_read_b64_tr_b16 v[94:95], v5 offset:2048
    ds_read_b64_tr_b16 v[96:97], v6 offset:0
    ds_read_b64_tr_b16 v[98:99], v6 offset:2048
    ds_read_b64_tr_b16 v[100:101], v3 offset:4096
    ds_read_b64_tr_b16 v[102:103], v3 offset:6144
    s_waitcnt vmcnt(34) lgkmcnt(8)
    v_mfma_f32_16x16x32_bf16 v[52:55], a[0:3], v[74:77], 0
    ds_read_b64_tr_b16 v[104:105], v4 offset:4096
    s_waitcnt lgkmcnt(7)
    ds_read_b64_tr_b16 v[106:107], v4 offset:6144
    v_mfma_f32_16x16x32_bf16 v[56:59], a[0:3], v[78:81], 0
    ds_read_b64_tr_b16 v[108:109], v5 offset:4096
    s_waitcnt lgkmcnt(7)
    ds_read_b64_tr_b16 v[110:111], v5 offset:6144
    v_mfma_f32_16x16x32_bf16 v[60:63], a[0:3], v[92:95], 0
    ds_read_b64_tr_b16 v[112:113], v6 offset:4096
    s_waitcnt lgkmcnt(7)
    ds_read_b64_tr_b16 v[114:115], v6 offset:6144
    v_mfma_f32_16x16x32_bf16 v[64:67], a[0:3], v[96:99], 0
    ds_read_b64_tr_b16 v[74:75], v3 offset:8192
    s_waitcnt lgkmcnt(7)
    ds_read_b64_tr_b16 v[76:77], v3 offset:10240
    s_waitcnt vmcnt(33)
    v_mfma_f32_16x16x32_bf16 v[52:55], a[4:7], v[100:103], v[52:55]
    ds_read_b64_tr_b16 v[78:79], v4 offset:8192
    s_waitcnt lgkmcnt(7)
    ds_read_b64_tr_b16 v[80:81], v4 offset:10240
    v_mfma_f32_16x16x32_bf16 v[56:59], a[4:7], v[104:107], v[56:59]
    ds_read_b64_tr_b16 v[92:93], v5 offset:8192
    s_waitcnt lgkmcnt(7)
    ds_read_b64_tr_b16 v[94:95], v5 offset:10240
    v_mfma_f32_16x16x32_bf16 v[60:63], a[4:7], v[108:111], v[60:63]
    ds_read_b64_tr_b16 v[96:97], v6 offset:8192
    s_waitcnt lgkmcnt(7)
    ds_read_b64_tr_b16 v[98:99], v6 offset:10240
    v_mfma_f32_16x16x32_bf16 v[64:67], a[4:7], v[112:115], v[64:67]
    ds_read_b64_tr_b16 v[100:101], v3 offset:12288
    s_waitcnt lgkmcnt(7)
    ds_read_b64_tr_b16 v[102:103], v3 offset:14336
    s_waitcnt vmcnt(32)
    v_mfma_f32_16x16x32_bf16 v[52:55], a[8:11], v[74:77], v[52:55]
    ds_read_b64_tr_b16 v[104:105], v4 offset:12288
    s_waitcnt lgkmcnt(7)
    ds_read_b64_tr_b16 v[106:107], v4 offset:14336
    v_mfma_f32_16x16x32_bf16 v[56:59], a[8:11], v[78:81], v[56:59]
    ds_read_b64_tr_b16 v[108:109], v5 offset:12288
    s_waitcnt lgkmcnt(7)
    ds_read_b64_tr_b16 v[110:111], v5 offset:14336
    v_mfma_f32_16x16x32_bf16 v[60:63], a[8:11], v[92:95], v[60:63]
    ds_read_b64_tr_b16 v[112:113], v6 offset:12288
    s_waitcnt lgkmcnt(7)
    ds_read_b64_tr_b16 v[114:115], v6 offset:14336
    v_mfma_f32_16x16x32_bf16 v[64:67], a[8:11], v[96:99], v[64:67]
    ds_read_b64_tr_b16 v[74:75], v3 offset:16384
    s_waitcnt lgkmcnt(7)
    ds_read_b64_tr_b16 v[76:77], v3 offset:18432
    s_waitcnt vmcnt(31)
    v_mfma_f32_16x16x32_bf16 v[52:55], a[12:15], v[100:103], v[52:55]
    ds_read_b64_tr_b16 v[78:79], v4 offset:16384
    s_waitcnt lgkmcnt(7)
    ds_read_b64_tr_b16 v[80:81], v4 offset:18432
    v_mfma_f32_16x16x32_bf16 v[56:59], a[12:15], v[104:107], v[56:59]
    ds_read_b64_tr_b16 v[92:93], v5 offset:16384
    s_waitcnt lgkmcnt(7)
    ds_read_b64_tr_b16 v[94:95], v5 offset:18432
    v_mfma_f32_16x16x32_bf16 v[60:63], a[12:15], v[108:111], v[60:63]
    ds_read_b64_tr_b16 v[96:97], v6 offset:16384
    s_waitcnt lgkmcnt(7)
    ds_read_b64_tr_b16 v[98:99], v6 offset:18432
    v_mfma_f32_16x16x32_bf16 v[64:67], a[12:15], v[112:115], v[64:67]
    ds_read_b64_tr_b16 v[100:101], v3 offset:20480
    s_waitcnt lgkmcnt(7)
    ds_read_b64_tr_b16 v[102:103], v3 offset:22528
    s_waitcnt vmcnt(30)
    v_mfma_f32_16x16x32_bf16 v[52:55], a[16:19], v[74:77], v[52:55]
    ds_read_b64_tr_b16 v[104:105], v4 offset:20480
    s_waitcnt lgkmcnt(7)
    ds_read_b64_tr_b16 v[106:107], v4 offset:22528
    v_mfma_f32_16x16x32_bf16 v[56:59], a[16:19], v[78:81], v[56:59]
    ds_read_b64_tr_b16 v[108:109], v5 offset:20480
    s_waitcnt lgkmcnt(7)
    ds_read_b64_tr_b16 v[110:111], v5 offset:22528
    v_mfma_f32_16x16x32_bf16 v[60:63], a[16:19], v[92:95], v[60:63]
    ds_read_b64_tr_b16 v[112:113], v6 offset:20480
    s_waitcnt lgkmcnt(7)
    ds_read_b64_tr_b16 v[114:115], v6 offset:22528
    v_mfma_f32_16x16x32_bf16 v[64:67], a[16:19], v[96:99], v[64:67]
    ds_read_b64_tr_b16 v[74:75], v3 offset:24576
    s_waitcnt lgkmcnt(7)
    ds_read_b64_tr_b16 v[76:77], v3 offset:26624
    s_waitcnt vmcnt(29)
    v_mfma_f32_16x16x32_bf16 v[52:55], a[20:23], v[100:103], v[52:55]
    ds_read_b64_tr_b16 v[78:79], v4 offset:24576
    s_waitcnt lgkmcnt(7)
    ds_read_b64_tr_b16 v[80:81], v4 offset:26624
    v_mfma_f32_16x16x32_bf16 v[56:59], a[20:23], v[104:107], v[56:59]
    ds_read_b64_tr_b16 v[92:93], v5 offset:24576
    s_waitcnt lgkmcnt(7)
    ds_read_b64_tr_b16 v[94:95], v5 offset:26624
    v_mfma_f32_16x16x32_bf16 v[60:63], a[20:23], v[108:111], v[60:63]
    ds_read_b64_tr_b16 v[96:97], v6 offset:24576
    s_waitcnt lgkmcnt(7)
    ds_read_b64_tr_b16 v[98:99], v6 offset:26624
    v_mfma_f32_16x16x32_bf16 v[64:67], a[20:23], v[112:115], v[64:67]
    ds_read_b64_tr_b16 v[100:101], v3 offset:28672
    s_waitcnt lgkmcnt(7)
    ds_read_b64_tr_b16 v[102:103], v3 offset:30720
    s_waitcnt vmcnt(28)
    v_mfma_f32_16x16x32_bf16 v[52:55], a[24:27], v[74:77], v[52:55]
    ds_read_b64_tr_b16 v[104:105], v4 offset:28672
    s_waitcnt lgkmcnt(7)
    ds_read_b64_tr_b16 v[106:107], v4 offset:30720
    v_mfma_f32_16x16x32_bf16 v[56:59], a[24:27], v[78:81], v[56:59]
    ds_read_b64_tr_b16 v[108:109], v5 offset:28672
    s_waitcnt lgkmcnt(7)
    ds_read_b64_tr_b16 v[110:111], v5 offset:30720
    v_mfma_f32_16x16x32_bf16 v[60:63], a[24:27], v[92:95], v[60:63]
    ds_read_b64_tr_b16 v[112:113], v6 offset:28672
    s_waitcnt lgkmcnt(7)
    ds_read_b64_tr_b16 v[114:115], v6 offset:30720
    v_mfma_f32_16x16x32_bf16 v[64:67], a[24:27], v[96:99], v[64:67]
    ds_read_b64_tr_b16 v[74:75], v3 offset:32768
    s_waitcnt lgkmcnt(7)
    ds_read_b64_tr_b16 v[76:77], v3 offset:34816
    s_waitcnt vmcnt(27)
    v_mfma_f32_16x16x32_bf16 v[52:55], a[28:31], v[100:103], v[52:55]
    ds_read_b64_tr_b16 v[78:79], v4 offset:32768
    s_waitcnt lgkmcnt(7)
    ds_read_b64_tr_b16 v[80:81], v4 offset:34816
    v_mfma_f32_16x16x32_bf16 v[56:59], a[28:31], v[104:107], v[56:59]
    ds_read_b64_tr_b16 v[92:93], v5 offset:32768
    s_waitcnt lgkmcnt(7)
    ds_read_b64_tr_b16 v[94:95], v5 offset:34816
    v_mfma_f32_16x16x32_bf16 v[60:63], a[28:31], v[108:111], v[60:63]
    ds_read_b64_tr_b16 v[96:97], v6 offset:32768
    s_waitcnt lgkmcnt(7)
    ds_read_b64_tr_b16 v[98:99], v6 offset:34816
    v_mfma_f32_16x16x32_bf16 v[64:67], a[28:31], v[112:115], v[64:67]
    ds_read_b64_tr_b16 v[100:101], v3 offset:36864
    v_readfirstlane_b32 s55, v8
    s_waitcnt lgkmcnt(7)
    ds_read_b64_tr_b16 v[102:103], v3 offset:38912
    s_waitcnt vmcnt(26)
    v_mfma_f32_16x16x32_bf16 v[52:55], a[32:35], v[74:77], v[52:55]
    ds_read_b64_tr_b16 v[104:105], v4 offset:36864
    v_lshrrev_b32 v72, 3, v1
    s_waitcnt lgkmcnt(7)
    ds_read_b64_tr_b16 v[106:107], v4 offset:38912
    v_mfma_f32_16x16x32_bf16 v[56:59], a[32:35], v[78:81], v[56:59]
    ds_read_b64_tr_b16 v[108:109], v5 offset:36864
    v_mov_b32 v68, -1
    s_waitcnt lgkmcnt(7)
    ds_read_b64_tr_b16 v[110:111], v5 offset:38912
    v_mfma_f32_16x16x32_bf16 v[60:63], a[32:35], v[92:95], v[60:63]
    ds_read_b64_tr_b16 v[112:113], v6 offset:36864
    v_mov_b32 v69, -1
    s_waitcnt lgkmcnt(7)
    ds_read_b64_tr_b16 v[114:115], v6 offset:38912
    v_mfma_f32_16x16x32_bf16 v[64:67], a[32:35], v[96:99], v[64:67]
    ds_read_b64_tr_b16 v[74:75], v3 offset:40960
    v_mov_b32 v70, -1
    s_waitcnt lgkmcnt(7)
    ds_read_b64_tr_b16 v[76:77], v3 offset:43008
    s_waitcnt vmcnt(25)
    v_mfma_f32_16x16x32_bf16 v[52:55], a[36:39], v[100:103], v[52:55]
    ds_read_b64_tr_b16 v[78:79], v4 offset:40960
    v_mov_b32 v71, -1
    s_waitcnt lgkmcnt(7)
    ds_read_b64_tr_b16 v[80:81], v4 offset:43008
    v_mfma_f32_16x16x32_bf16 v[56:59], a[36:39], v[104:107], v[56:59]
    ds_read_b64_tr_b16 v[92:93], v5 offset:40960
    v_mul_u32_u24 v72, 8064, v72
    s_waitcnt lgkmcnt(7)
    ds_read_b64_tr_b16 v[94:95], v5 offset:43008
    v_mfma_f32_16x16x32_bf16 v[60:63], a[36:39], v[108:111], v[60:63]
    ds_read_b64_tr_b16 v[96:97], v6 offset:40960
    s_add_u32 s55, s55, 0x400000
    s_waitcnt lgkmcnt(7)
    ds_read_b64_tr_b16 v[98:99], v6 offset:43008
    v_mfma_f32_16x16x32_bf16 v[64:67], a[36:39], v[112:115], v[64:67]
    ds_read_b64_tr_b16 v[100:101], v3 offset:45056
    v_add_u32 v72, v72, v2
    s_waitcnt lgkmcnt(7)
    ds_read_b64_tr_b16 v[102:103], v3 offset:47104
    s_waitcnt vmcnt(24)
    v_mfma_f32_16x16x32_bf16 v[52:55], a[40:43], v[74:77], v[52:55]
    ds_read_b64_tr_b16 v[104:105], v4 offset:45056
    buffer_store_dwordx4 v[68:71], v72, s[36:39], s55 offen sc1
    s_waitcnt lgkmcnt(7)
    ds_read_b64_tr_b16 v[106:107], v4 offset:47104
    v_mfma_f32_16x16x32_bf16 v[56:59], a[40:43], v[78:81], v[56:59]
    ds_read_b64_tr_b16 v[108:109], v5 offset:45056
    s_waitcnt lgkmcnt(7)
    ds_read_b64_tr_b16 v[110:111], v5 offset:47104
    v_mfma_f32_16x16x32_bf16 v[60:63], a[40:43], v[92:95], v[60:63]
    ds_read_b64_tr_b16 v[112:113], v6 offset:45056
    s_waitcnt lgkmcnt(7)
    ds_read_b64_tr_b16 v[114:115], v6 offset:47104
    v_mfma_f32_16x16x32_bf16 v[64:67], a[40:43], v[96:99], v[64:67]
    ds_read_b64_tr_b16 v[74:75], v3 offset:49152
    s_waitcnt lgkmcnt(7)
    ds_read_b64_tr_b16 v[76:77], v3 offset:51200
    s_waitcnt vmcnt(24)
    v_mfma_f32_16x16x32_bf16 v[52:55], a[44:47], v[100:103], v[52:55]
    ds_read_b64_tr_b16 v[78:79], v4 offset:49152
    s_add_u32 s55, s55, 0x10000
    s_waitcnt lgkmcnt(7)
    ds_read_b64_tr_b16 v[80:81], v4 offset:51200
    v_mfma_f32_16x16x32_bf16 v[56:59], a[44:47], v[104:107], v[56:59]
    ds_read_b64_tr_b16 v[92:93], v5 offset:49152
    buffer_store_dwordx4 v[68:71], v72, s[36:39], s55 offen sc1
    s_waitcnt lgkmcnt(7)
    ds_read_b64_tr_b16 v[94:95], v5 offset:51200
    v_mfma_f32_16x16x32_bf16 v[60:63], a[44:47], v[108:111], v[60:63]
    ds_read_b64_tr_b16 v[96:97], v6 offset:49152
    s_waitcnt lgkmcnt(7)
    ds_read_b64_tr_b16 v[98:99], v6 offset:51200
    v_mfma_f32_16x16x32_bf16 v[64:67], a[44:47], v[112:115], v[64:67]
    ds_read_b64_tr_b16 v[100:101], v3 offset:53248
    s_waitcnt lgkmcnt(7)
    ds_read_b64_tr_b16 v[102:103], v3 offset:55296
    s_waitcnt vmcnt(24)
    v_mfma_f32_16x16x32_bf16 v[52:55], a[48:51], v[74:77], v[52:55]
    ds_read_b64_tr_b16 v[104:105], v4 offset:53248
    s_and_b32 s55, s55, 0x1fff
    s_waitcnt lgkmcnt(7)
    ds_read_b64_tr_b16 v[106:107], v4 offset:55296
    v_mfma_f32_16x16x32_bf16 v[56:59], a[48:51], v[78:81], v[56:59]
    ds_read_b64_tr_b16 v[108:109], v5 offset:53248
    s_add_u32 s55, s55, s8
    s_waitcnt lgkmcnt(7)
    ds_read_b64_tr_b16 v[110:111], v5 offset:55296
    v_mfma_f32_16x16x32_bf16 v[60:63], a[48:51], v[92:95], v[60:63]
    ds_read_b64_tr_b16 v[112:113], v6 offset:53248
    s_mov_b64 exec, 0xff
    buffer_store_dwordx4 v[68:71], v2, s[36:39], s55 offen sc1
    s_mov_b64 exec, -1
    s_waitcnt lgkmcnt(7)
    ds_read_b64_tr_b16 v[114:115], v6 offset:55296
    v_mfma_f32_16x16x32_bf16 v[64:67], a[48:51], v[96:99], v[64:67]
    ds_read_b64_tr_b16 v[74:75], v3 offset:57344
    s_waitcnt lgkmcnt(7)
    ds_read_b64_tr_b16 v[76:77], v3 offset:59392
    s_waitcnt vmcnt(24)
    v_mfma_f32_16x16x32_bf16 v[52:55], a[52:55], v[100:103], v[52:55]
    ds_read_b64_tr_b16 v[78:79], v4 offset:57344
    s_waitcnt lgkmcnt(7)
    ds_read_b64_tr_b16 v[80:81], v4 offset:59392
    v_mfma_f32_16x16x32_bf16 v[56:59], a[52:55], v[104:107], v[56:59]
    ds_read_b64_tr_b16 v[92:93], v5 offset:57344
    s_waitcnt lgkmcnt(7)
    ds_read_b64_tr_b16 v[94:95], v5 offset:59392
    v_mfma_f32_16x16x32_bf16 v[60:63], a[52:55], v[108:111], v[60:63]
    ds_read_b64_tr_b16 v[96:97], v6 offset:57344
    s_waitcnt lgkmcnt(7)
    ds_read_b64_tr_b16 v[98:99], v6 offset:59392
    v_mfma_f32_16x16x32_bf16 v[64:67], a[52:55], v[112:115], v[64:67]
    ds_read_b64_tr_b16 v[100:101], v3 offset:61440
    s_waitcnt lgkmcnt(7)
    ds_read_b64_tr_b16 v[102:103], v3 offset:63488
    s_waitcnt vmcnt(23)
    v_mfma_f32_16x16x32_bf16 v[52:55], a[56:59], v[74:77], v[52:55]
    ds_read_b64_tr_b16 v[104:105], v4 offset:61440
    s_waitcnt lgkmcnt(7)
    ds_read_b64_tr_b16 v[106:107], v4 offset:63488
    v_mfma_f32_16x16x32_bf16 v[56:59], a[56:59], v[78:81], v[56:59]
    ds_read_b64_tr_b16 v[108:109], v5 offset:61440
    s_waitcnt lgkmcnt(7)
    ds_read_b64_tr_b16 v[110:111], v5 offset:63488
    v_mfma_f32_16x16x32_bf16 v[60:63], a[56:59], v[92:95], v[60:63]
    ds_read_b64_tr_b16 v[112:113], v6 offset:61440
    s_waitcnt lgkmcnt(7)
    ds_read_b64_tr_b16 v[114:115], v6 offset:63488
    v_mfma_f32_16x16x32_bf16 v[64:67], a[56:59], v[96:99], v[64:67]
    s_waitcnt lgkmcnt(6)
    s_waitcnt vmcnt(22)
    v_mfma_f32_16x16x32_bf16 v[52:55], a[60:63], v[100:103], v[52:55]
    s_waitcnt lgkmcnt(4)
    v_mfma_f32_16x16x32_bf16 v[56:59], a[60:63], v[104:107], v[56:59]
    s_waitcnt lgkmcnt(2)
    v_mfma_f32_16x16x32_bf16 v[60:63], a[60:63], v[108:111], v[60:63]
    s_waitcnt lgkmcnt(0)
    v_mfma_f32_16x16x32_bf16 v[64:67], a[60:63], v[112:115], v[64:67]
    s_nop 0
    s_mov_b32 s53, 0xa00000
    v_xor_b32 v69, 512, v21
    v_xor_b32 v70, 32768, v21
    v_xor_b32 v71, 33280, v21
    v_pk_fma_f32 v[84:85], v[124:125], v[42:43], s[66:67] op_sel:[1,0,0] op_sel_hi:[1,1,0] neg_lo:[1,0,0] neg_hi:[1,0,0]
    v_pk_fma_f32 v[86:87], v[124:125], v[44:45], s[66:67] op_sel:[1,0,0] op_sel_hi:[1,1,0] neg_lo:[1,0,0] neg_hi:[1,0,0]
    v_pk_fma_f32 v[52:53], v[52:53], v[124:125], v[84:85] op_sel:[0,0,0] op_sel_hi:[1,0,1]
    v_pk_fma_f32 v[54:55], v[54:55], v[124:125], v[86:87] op_sel:[0,0,0] op_sel_hi:[1,0,1]
    v_pk_fma_f32 v[84:85], v[52:53], s[64:65], s[64:65] op_sel:[0,0,1] op_sel_hi:[1,0,1]
    v_pk_fma_f32 v[86:87], v[54:55], s[64:65], s[64:65] op_sel:[0,0,1] op_sel_hi:[1,0,1]
    v_exp_f32_e64 v84, v84 clamp
    v_exp_f32_e64 v85, v85 clamp
    v_exp_f32_e64 v86, v86 clamp
    v_exp_f32_e64 v87, v87 clamp
    v_max_f32 v52, s66, v52
    v_max_f32 v53, s66, v53
    v_max_f32 v54, s66, v54
    v_max_f32 v55, s66, v55
    v_pk_add_f32 v[52:53], v[52:53], v[84:85] op_sel:[0,0] op_sel_hi:[1,1]
    v_pk_add_f32 v[54:55], v[54:55], v[86:87] op_sel:[0,0] op_sel_hi:[1,1]
    v_cvt_pk_bf16_f32 v52, v52, v53
    v_cvt_pk_bf16_f32 v53, v54, v55
    buffer_store_dwordx2 v[52:53], v21, s[36:39], s53 offen sc1
    v_pk_fma_f32 v[84:85], v[126:127], v[42:43], s[66:67] op_sel:[1,0,0] op_sel_hi:[1,1,0] neg_lo:[1,0,0] neg_hi:[1,0,0]
    v_pk_fma_f32 v[86:87], v[126:127], v[44:45], s[66:67] op_sel:[1,0,0] op_sel_hi:[1,1,0] neg_lo:[1,0,0] neg_hi:[1,0,0]
    v_pk_fma_f32 v[56:57], v[56:57], v[126:127], v[84:85] op_sel:[0,0,0] op_sel_hi:[1,0,1]
    v_pk_fma_f32 v[58:59], v[58:59], v[126:127], v[86:87] op_sel:[0,0,0] op_sel_hi:[1,0,1]
    v_pk_fma_f32 v[84:85], v[56:57], s[64:65], s[64:65] op_sel:[0,0,1] op_sel_hi:[1,0,1]
    v_pk_fma_f32 v[86:87], v[58:59], s[64:65], s[64:65] op_sel:[0,0,1] op_sel_hi:[1,0,1]
    v_exp_f32_e64 v84, v84 clamp
    v_exp_f32_e64 v85, v85 clamp
    v_exp_f32_e64 v86, v86 clamp
    v_exp_f32_e64 v87, v87 clamp
    v_max_f32 v56, s66, v56
    v_max_f32 v57, s66, v57
    v_max_f32 v58, s66, v58
    v_max_f32 v59, s66, v59
    v_pk_add_f32 v[56:57], v[56:57], v[84:85] op_sel:[0,0] op_sel_hi:[1,1]
    v_pk_add_f32 v[58:59], v[58:59], v[86:87] op_sel:[0,0] op_sel_hi:[1,1]
    v_cvt_pk_bf16_f32 v56, v56, v57
    v_cvt_pk_bf16_f32 v57, v58, v59
    buffer_store_dwordx2 v[56:57], v69, s[36:39], s53 offen sc1
    s_waitcnt vmcnt(5)
    s_barrier
    s_cmp_lg_u32 s48, 0
    s_cbranch_scc1 L_arr2
    v_mov_b32 v50, 1
    s_mov_b32 exec_hi, 0
    buffer_atomic_add v50, v32, s[36:39], 0 offen
    s_mov_b64 exec, -1
L_arr2:
    s_nop 0
    v_pk_fma_f32 v[84:85], v[128:129], v[42:43], s[66:67] op_sel:[1,0,0] op_sel_hi:[1,1,0] neg_lo:[1,0,0] neg_hi:[1,0,0]
    v_pk_fma_f32 v[86:87], v[128:129], v[44:45], s[66:67] op_sel:[1,0,0] op_sel_hi:[1,1,0] neg_lo:[1,0,0] neg_hi:[1,0,0]
    v_pk_fma_f32 v[60:61], v[60:61], v[128:129], v[84:85] op_sel:[0,0,0] op_sel_hi:[1,0,1]
    v_pk_fma_f32 v[62:63], v[62:63], v[128:129], v[86:87] op_sel:[0,0,0] op_sel_hi:[1,0,1]
    v_pk_fma_f32 v[84:85], v[60:61], s[64:65], s[64:65] op_sel:[0,0,1] op_sel_hi:[1,0,1]
    v_pk_fma_f32 v[86:87], v[62:63], s[64:65], s[64:65] op_sel:[0,0,1] op_sel_hi:[1,0,1]
    v_exp_f32_e64 v84, v84 clamp
    v_exp_f32_e64 v85, v85 clamp
    v_exp_f32_e64 v86, v86 clamp
    v_exp_f32_e64 v87, v87 clamp
    v_max_f32 v60, s66, v60
    v_max_f32 v61, s66, v61
    v_max_f32 v62, s66, v62
    v_max_f32 v63, s66, v63
    v_pk_add_f32 v[60:61], v[60:61], v[84:85] op_sel:[0,0] op_sel_hi:[1,1]
    v_pk_add_f32 v[62:63], v[62:63], v[86:87] op_sel:[0,0] op_sel_hi:[1,1]
    v_cvt_pk_bf16_f32 v60, v60, v61
    v_cvt_pk_bf16_f32 v61, v62, v63
    buffer_store_dwordx2 v[60:61], v70, s[36:39], s53 offen sc1
    v_pk_fma_f32 v[84:85], v[130:131], v[42:43], s[66:67] op_sel:[1,0,0] op_sel_hi:[1,1,0] neg_lo:[1,0,0] neg_hi:[1,0,0]
    v_pk_fma_f32 v[86:87], v[130:131], v[44:45], s[66:67] op_sel:[1,0,0] op_sel_hi:[1,1,0] neg_lo:[1,0,0] neg_hi:[1,0,0]
    v_pk_fma_f32 v[64:65], v[64:65], v[130:131], v[84:85] op_sel:[0,0,0] op_sel_hi:[1,0,1]
    v_pk_fma_f32 v[66:67], v[66:67], v[130:131], v[86:87] op_sel:[0,0,0] op_sel_hi:[1,0,1]
    v_pk_fma_f32 v[84:85], v[64:65], s[64:65], s[64:65] op_sel:[0,0,1] op_sel_hi:[1,0,1]
    v_pk_fma_f32 v[86:87], v[66:67], s[64:65], s[64:65] op_sel:[0,0,1] op_sel_hi:[1,0,1]
    v_exp_f32_e64 v84, v84 clamp
    v_exp_f32_e64 v85, v85 clamp
    v_exp_f32_e64 v86, v86 clamp
    v_exp_f32_e64 v87, v87 clamp
    v_max_f32 v64, s66, v64
    v_max_f32 v65, s66, v65
    v_max_f32 v66, s66, v66
    v_max_f32 v67, s66, v67
    v_pk_add_f32 v[64:65], v[64:65], v[84:85] op_sel:[0,0] op_sel_hi:[1,1]
    v_pk_add_f32 v[66:67], v[66:67], v[86:87] op_sel:[0,0] op_sel_hi:[1,1]
    v_cvt_pk_bf16_f32 v64, v64, v65
    v_cvt_pk_bf16_f32 v65, v66, v67
    buffer_store_dwordx2 v[64:65], v71, s[36:39], s53 offen sc1
    s_xor_b32 s68, s0, 0xee8000
    buffer_load_dwordx4 v[232:235], v39, s[36:39], s68 offen sc1
    s_xor_b32 s68, s0, 0xeec000
    buffer_load_dwordx4 v[236:239], v39, s[36:39], s68 offen sc1
    s_xor_b32 s68, s0, 0xe90000
    buffer_load_dwordx4 a[208:211], v39, s[36:39], s68 offen sc1
    s_xor_b32 s68, s0, 0xe94000
    buffer_load_dwordx4 a[212:215], v39, s[36:39], s68 offen sc1
    s_xor_b32 s68, s0, 0xeb0000
    buffer_load_dwordx4 a[240:243], v39, s[36:39], s68 offen sc1
    s_xor_b32 s68, s0, 0xeb4000
    buffer_load_dwordx4 a[244:247], v39, s[36:39], s68 offen sc1
    s_cmp_lg_u32 s48, 0
    s_cbranch_scc1 L_ps3
    s_mov_b64 exec, 0xff
    v_mov_b32_e64 v34, 0
    buffer_atomic_add v34, v33, s[36:39], 0 offen sc0
    s_mov_b64 exec, -1
L_ps3:
    v_and_b32 v36, 15, v1
    v_lshrrev_b32 v37, 4, v1
    v_lshrrev_b32 v38, 5, v1
    s_mov_b32 s58, 0xffff0000
    s_mov_b32 s59, 0xffff0000
    v_and_b32 v9, 0x1fff, v8
    v_lshl_add_u32 v9, v38, 13, v9
    s_lshl_b32 s53, s49, 1
    s_add_u32 s53, s53, s52
    s_lshl_b32 s53, s53, 15
    s_lshl_b32 s54, s48, 13
    s_add_u32 s53, s53, s54
    v_and_b32 v50, 31, v1
    v_lshl_add_u32 v24, v50, 5, s53
    v_lshl_add_u32 v24, v38, 4, v24
    v_add_u32 v27, s54, v2
    v_and_b32 v50, 3, v36
    v_lshl_add_u32 v25, v50, 4, s54
    v_lshl_add_u32 v25, v38, 6, v25
    v_bfe_u32 v51, v1, 2, 3
    v_lshl_add_u32 v25, v51, 7, v25
    v_lshrrev_b32 v51, 3, v36
    s_lshl_b32 s53, s48, 11
    s_add_u32 s53, s53, 32768
    v_lshl_add_u32 v26, v51, 10, s53
    v_lshl_add_u32 v26, v50, 8, v26
    v_lshl_add_u32 v26, v37, 4, v26
    v_add_u32 v27, 65536, v27
    s_lshl_b32 s53, s51, 14
    s_lshl_b32 s54, s48, 12
    s_add_u32 s53, s53, s54
    s_lshl_b32 s54, s52, 6
    s_add_u32 s53, s53, s54
    v_lshl_add_u32 v28, v38, 11, s53
    v_lshl_add_u32 v28, v50, 3, v28
    v_lshrrev_b32 v50, 2, v36
    v_lshl_add_u32 v28, v50, 7, v28
    v_xor_b32 v51, v51, v37
    v_and_b32 v51, 1, v51
    v_lshl_add_u32 v28, v51, 5, v28
    v_xor_b32_e64 v29, 64, v28
    ds_read_b64_tr_b16 v[50:51], v28 offset:0
    ds_read_b64_tr_b16 v[52:53], v29 offset:512
    ds_read_b64_tr_b16 v[54:55], v28 offset:1024
    ds_read_b64_tr_b16 v[56:57], v29 offset:1536
    s_mov_b32 s54, 0x10000
    s_mov_b32 s55, 0xa00000
    s_mov_b32 s68, 0x11000
    s_mov_b32 s69, 0xa01000
    v_xor_b32 v36, 8192, v27
    v_xor_b32 v37, 16384, v27
    v_xor_b32 v38, 24576, v27
    s_waitcnt lgkmcnt(3)
    v_lshlrev_b32 v58, 16, v50
    v_and_b32 v59, 0xffff0000, v50
    v_lshlrev_b32_e64 v60, 16, v51
    v_and_b32 v61, 0xffff0000, v51
    s_waitcnt lgkmcnt(2)
    v_lshlrev_b32 v62, 16, v52
    v_and_b32 v63, 0xffff0000, v52
    v_lshlrev_b32_e64 v64, 16, v53
    v_and_b32 v65, 0xffff0000, v53
    s_waitcnt lgkmcnt(1)
    v_lshlrev_b32 v66, 16, v54
    v_and_b32 v67, 0xffff0000, v54
    v_lshlrev_b32_e64 v68, 16, v55
    v_and_b32 v69, 0xffff0000, v55
    s_waitcnt lgkmcnt(0)
    v_lshlrev_b32 v70, 16, v56
    v_and_b32 v71, 0xffff0000, v56
    v_lshlrev_b32_e64 v72, 16, v57
    v_and_b32 v73, 0xffff0000, v57
    s_mov_b32 s67, s48
    s_branch L_pg4
.p2align 12
L_pg4:
    s_cmp_lg_u32 s48, 0
    s_cbranch_scc0 L_wait3_w0
    s_branch L_wait3
L_wait3_w0:
    s_mov_b64 exec, 0xff
    s_movk_i32 s53, 96
    s_mov_b32 s61, 0x100000
L_wait3_poll:
    v_mov_b32_e64 v35, 0
    buffer_atomic_add v35, v33, s[36:39], 0 offen sc0
    s_waitcnt vmcnt(1)
    v_cmp_gt_u32 vcc, s53, v34
    s_cbranch_vccz L_wait3_done
    v_mov_b32 v34, 0
    buffer_atomic_add v34, v33, s[36:39], 0 offen sc0
    s_sub_u32 s61, s61, 1
    s_cbranch_scc1 L_wait3_done
    s_waitcnt vmcnt(1)
    v_cmp_gt_u32 vcc, s53, v35
    s_cbranch_vccnz L_wait3_poll
L_wait3_done:
    s_mov_b64 exec, -1
L_wait3:
    s_barrier
L_redoq0:
    buffer_load_dwordx4 v[54:57], v26, s[36:39], s54 offen sc1
    buffer_load_dwordx4 v[74:77], v25, s[36:39], s54 offen offset:0 sc1
    buffer_load_dwordx4 v[78:81], v25, s[36:39], s54 offen offset:1024 sc1
    s_barrier
    buffer_load_dwordx4 v[106:109], v24, s[36:39], s55 offen offset:0 sc1
    buffer_load_dwordx4 v[110:113], v24, s[36:39], s55 offen offset:1024 sc1
    s_barrier
    buffer_load_dwordx4 v[82:85], v25, s[36:39], s54 offen offset:2048 sc1
    buffer_load_dwordx4 v[86:89], v25, s[36:39], s54 offen offset:3072 sc1
    buffer_load_dwordx4 v[114:117], v24, s[36:39], s55 offen offset:2048 sc1
    buffer_load_dwordx4 v[118:121], v24, s[36:39], s55 offen offset:3072 sc1
    s_barrier
    buffer_load_dwordx4 v[90:93], v25, s[36:39], s68 offen offset:0 sc1
    buffer_load_dwordx4 v[94:97], v25, s[36:39], s68 offen offset:1024 sc1
    buffer_load_dwordx4 v[122:125], v24, s[36:39], s69 offen offset:0 sc1
    buffer_load_dwordx4 v[126:129], v24, s[36:39], s69 offen offset:1024 sc1
    s_waitcnt vmcnt(12)
    v_cvt_pk_bf16_f32 v50, v54, v55
    v_cvt_pk_bf16_f32 v51, v56, v57
    v_cvt_pk_bf16_f32 v52, v54, v55
    v_cvt_pk_bf16_f32 v53, v56, v57
    s_waitcnt vmcnt(11)
    v_cvt_pk_bf16_f32 v74, v74, v75
    v_cvt_pk_bf16_f32 v75, v76, v77
    s_waitcnt vmcnt(10)
    v_cvt_pk_bf16_f32 v76, v78, v79
    v_cvt_pk_bf16_f32 v77, v80, v81
    v_permlane16_swap_b32 v50, v52
    v_permlane16_swap_b32 v51, v53
    s_nop 0
    v_cndmask_b32 v78, v50, v74, s[58:59]
    v_cndmask_b32 v79, v51, v75, s[58:59]
    v_cndmask_b32 v80, v52, v76, s[58:59]
    v_cndmask_b32 v81, v53, v77, s[58:59]
    v_cndmask_b32 v74, v74, v50, s[58:59]
    v_cndmask_b32 v75, v75, v51, s[58:59]
    v_cndmask_b32 v76, v76, v52, s[58:59]
    v_cndmask_b32 v77, v77, v53, s[58:59]
    s_waitcnt vmcnt(9)
    s_nop 0
    v_mfma_f32_32x32x16_bf16 v[138:153], v[74:77], v[106:109], 0
    s_waitcnt vmcnt(8)
    v_mfma_f32_32x32x16_bf16 v[154:169], v[78:81], v[110:113], 0
    buffer_load_dwordx4 v[98:101], v25, s[36:39], s68 offen offset:2048 sc1
    buffer_load_dwordx4 v[102:105], v25, s[36:39], s68 offen offset:3072 sc1
    buffer_load_dwordx4 v[130:133], v24, s[36:39], s69 offen offset:2048 sc1
    buffer_load_dwordx4 v[134:137], v24, s[36:39], s69 offen offset:3072 sc1
    s_nop 5
    v_add_f32 v146, s66, v146
    v_rcp_f32 v146, v146
    v_add_f32 v155, s66, v155
    v_rcp_f32 v155, v155
    v_mul_f32 v138, v146, v138
    v_mul_f32 v139, v146, v139
    v_mul_f32 v140, v146, v140
    v_mul_f32 v141, v146, v141
    v_mul_f32 v142, v146, v142
    v_mul_f32 v143, v146, v143
    v_mul_f32 v144, v146, v144
    v_mul_f32 v145, v146, v145
    v_cvt_pk_bf16_f32 v106, v138, v139
    v_cvt_pk_bf16_f32 v107, v140, v141
    v_cvt_pk_bf16_f32 v108, v142, v143
    v_cvt_pk_bf16_f32 v109, v144, v145
    ds_write_b128 v27, v[106:109] offset:0
    v_mul_f32 v162, v155, v162
    v_mul_f32 v163, v155, v163
    v_mul_f32 v164, v155, v164
    v_mul_f32 v165, v155, v165
    v_mul_f32 v166, v155, v166
    v_mul_f32 v167, v155, v167
    v_mul_f32 v168, v155, v168
    v_mul_f32 v169, v155, v169
    v_cvt_pk_bf16_f32 v110, v162, v163
    v_cvt_pk_bf16_f32 v111, v164, v165
    v_cvt_pk_bf16_f32 v112, v166, v167
    v_cvt_pk_bf16_f32 v113, v168, v169
    ds_write_b128 v27, v[110:113] offset:1024
    s_waitcnt vmcnt(11)
    v_cvt_pk_bf16_f32 v82, v82, v83
    v_cvt_pk_bf16_f32 v83, v84, v85
    s_waitcnt vmcnt(10)
    v_cvt_pk_bf16_f32 v84, v86, v87
    v_cvt_pk_bf16_f32 v85, v88, v89
    v_cndmask_b32 v86, v50, v82, s[58:59]
    v_cndmask_b32 v87, v51, v83, s[58:59]
    v_cndmask_b32 v88, v52, v84, s[58:59]
    v_cndmask_b32 v89, v53, v85, s[58:59]
    v_cndmask_b32 v82, v82, v50, s[58:59]
    v_cndmask_b32 v83, v83, v51, s[58:59]
    v_cndmask_b32 v84, v84, v52, s[58:59]
    v_cndmask_b32 v85, v85, v53, s[58:59]
    s_waitcnt lgkmcnt(0)
    s_barrier
    s_cmp_lg_u32 s67, 1
    s_cbranch_scc1 L_nofbq0
    s_mov_b32 s53, 0x2c000
    v_mov_b32 v34, 1
    s_mov_b64 exec, 1
    buffer_atomic_add v34, v32, s[36:39], s53 offen
    s_mov_b64 exec, -1
L_nofbq0:
    s_waitcnt vmcnt(9)
    v_mfma_f32_32x32x16_bf16 v[138:153], v[82:85], v[114:117], 0
    ds_read_b128 v[54:57], v36 offset:0
    ds_read_b128 v[170:173], v36 offset:1024
    ds_read_b128 v[174:177], v37 offset:0
    s_waitcnt vmcnt(8)
    v_mfma_f32_32x32x16_bf16 v[154:169], v[86:89], v[118:121], 0
    ds_read_b128 v[178:181], v37 offset:1024
    ds_read_b128 v[182:185], v38 offset:0
    ds_read_b128 v[186:189], v38 offset:1024
    v_mfma_f32_32x32x16_bf16 v[58:73], a[192:195], v[106:109], v[58:73]
    s_nop 2
    v_add_f32_e64 v148, s66, v148
    v_mfma_f32_32x32x16_bf16 v[58:73], a[196:199], v[110:113], v[58:73]
    v_rcp_f32 v148, v148
    s_nop 1
    v_add_f32_e64 v157, s66, v157
    s_xor_b32 s68, s0, 0xed0000
    buffer_load_dwordx4 v[208:211], v39, s[36:39], s68 offen sc1
    v_rcp_f32 v157, v157
    v_mul_f32 v138, v148, v138
    v_mul_f32 v139, v148, v139
    s_waitcnt lgkmcnt(3)
    v_mfma_f32_32x32x16_bf16 v[58:73], a[224:227], v[54:57], v[58:73]
    v_mul_f32 v140, v148, v140
    v_mul_f32 v141, v148, v141
    v_mul_f32_e64 v142, v148, v142
    s_xor_b32 s68, s0, 0xed4000
    buffer_load_dwordx4 v[212:215], v39, s[36:39], s68 offen sc1
    v_mul_f32 v143, v148, v143
    v_mul_f32 v144, v148, v144
    v_mfma_f32_32x32x16_bf16 v[58:73], a[228:231], v[170:173], v[58:73]
    v_mul_f32_e64 v145, v148, v145
    v_cvt_pk_bf16_f32 v114, v138, v139
    v_cvt_pk_bf16_f32 v115, v140, v141
    v_cvt_pk_bf16_f32 v116, v142, v143
    s_xor_b32 s68, s0, 0xef0000
    buffer_load_dwordx4 v[240:243], v39, s[36:39], s68 offen sc1
    v_cvt_pk_bf16_f32 v117, v144, v145
    v_mfma_f32_32x32x16_bf16 v[58:73], v[192:195], v[174:177], v[58:73]
    ds_write_b128 v27, v[114:117] offset:2048
    v_mul_f32 v162, v157, v162
    v_mul_f32 v163, v157, v163
    v_mul_f32 v164, v157, v164
    v_mul_f32 v165, v157, v165
    s_xor_b32 s68, s0, 0xef4000
    buffer_load_dwordx4 v[244:247], v39, s[36:39], s68 offen sc1
    v_mul_f32 v166, v157, v166
    s_waitcnt lgkmcnt(1)
    v_mfma_f32_32x32x16_bf16 v[58:73], v[196:199], v[178:181], v[58:73]
    v_mul_f32 v167, v157, v167
    v_mul_f32 v168, v157, v168
    v_mul_f32_e64 v169, v157, v169
    v_cvt_pk_bf16_f32 v118, v162, v163
    v_cvt_pk_bf16_f32 v119, v164, v165
    s_xor_b32 s68, s0, 0xe98000
    buffer_load_dwordx4 a[216:219], v39, s[36:39], s68 offen sc1
    v_cvt_pk_bf16_f32 v120, v166, v167
    v_cvt_pk_bf16_f32 v121, v168, v169
    v_mfma_f32_32x32x16_bf16 v[58:73], v[224:227], v[182:185], v[58:73]
    ds_write_b128 v27, v[118:121] offset:3072
    s_waitcnt vmcnt(12)
    v_cvt_pk_bf16_f32 v90, v90, v91
    v_cvt_pk_bf16_f32 v91, v92, v93
    s_waitcnt vmcnt(11)
    v_cvt_pk_bf16_f32 v92, v94, v95
    s_xor_b32 s68, s0, 0xe9c000
    buffer_load_dwordx4 a[220:223], v39, s[36:39], s68 offen sc1
    v_cvt_pk_bf16_f32 v93, v96, v97
    v_mfma_f32_32x32x16_bf16 v[58:73], v[228:231], v[186:189], v[58:73]
    v_cndmask_b32 v94, v50, v90, s[58:59]
    v_cndmask_b32 v95, v51, v91, s[58:59]
    v_cndmask_b32 v96, v52, v92, s[58:59]
    v_cndmask_b32 v97, v53, v93, s[58:59]
    v_cndmask_b32 v90, v90, v50, s[58:59]
    s_xor_b32 s68, s0, 0xeb8000
    buffer_load_dwordx4 a[248:251], v39, s[36:39], s68 offen sc1
    v_cndmask_b32 v91, v91, v51, s[58:59]
    v_cndmask_b32 v92, v92, v52, s[58:59]
    v_cndmask_b32 v93, v93, v53, s[58:59]
    s_waitcnt lgkmcnt(0)
    s_barrier
    s_waitcnt vmcnt(12)
    v_mfma_f32_32x32x16_bf16 v[138:153], v[90:93], v[122:125], 0
    ds_read_b128 v[54:57], v36 offset:2048
    ds_read_b128 v[170:173], v36 offset:3072
    ds_read_b128 v[174:177], v37 offset:2048
    s_waitcnt vmcnt(11)
    v_mfma_f32_32x32x16_bf16 v[154:169], v[94:97], v[126:129], 0
    ds_read_b128 v[178:181], v37 offset:3072
    ds_read_b128 v[182:185], v38 offset:2048
    ds_read_b128 v[186:189], v38 offset:3072
    v_mfma_f32_32x32x16_bf16 v[58:73], a[200:203], v[114:117], v[58:73]
    s_nop 2
    v_add_f32 v150, s66, v150
    v_mfma_f32_32x32x16_bf16 v[58:73], a[204:207], v[118:121], v[58:73]
    v_rcp_f32 v150, v150
    s_nop 1
    v_add_f32_e64 v159, s66, v159
    s_xor_b32 s68, s0, 0xebc000
    buffer_load_dwordx4 a[252:255], v39, s[36:39], s68 offen sc1
    v_rcp_f32 v159, v159
    v_mul_f32 v138, v150, v138
    v_mul_f32 v139, v150, v139
    s_waitcnt lgkmcnt(3)
    v_mfma_f32_32x32x16_bf16 v[58:73], a[232:235], v[54:57], v[58:73]
    v_mul_f32 v140, v150, v140
    v_mul_f32 v141, v150, v141
    v_mul_f32_e64 v142, v150, v142
    s_xor_b32 s68, s0, 0xed8000
    buffer_load_dwordx4 v[216:219], v39, s[36:39], s68 offen sc1
    v_mul_f32 v143, v150, v143
    v_mul_f32 v144, v150, v144
    v_mfma_f32_32x32x16_bf16 v[58:73], a[236:239], v[170:173], v[58:73]
    v_mul_f32_e64 v145, v150, v145
    v_cvt_pk_bf16_f32 v122, v138, v139
    v_cvt_pk_bf16_f32 v123, v140, v141
    v_cvt_pk_bf16_f32 v124, v142, v143
    s_xor_b32 s68, s0, 0xedc000
    buffer_load_dwordx4 v[220:223], v39, s[36:39], s68 offen sc1
    v_cvt_pk_bf16_f32 v125, v144, v145
    v_mfma_f32_32x32x16_bf16 v[58:73], v[200:203], v[174:177], v[58:73]
    ds_write_b128 v27, v[122:125] offset:4096
    v_mul_f32 v162, v159, v162
    v_mul_f32 v163, v159, v163
    v_mul_f32 v164, v159, v164
    v_mul_f32 v165, v159, v165
    s_xor_b32 s68, s0, 0xef8000
    buffer_load_dwordx4 v[248:251], v39, s[36:39], s68 offen sc1
    v_mul_f32 v166, v159, v166
    s_waitcnt lgkmcnt(1)
    v_mfma_f32_32x32x16_bf16 v[58:73], v[204:207], v[178:181], v[58:73]
    v_mul_f32 v167, v159, v167
    v_mul_f32 v168, v159, v168
    v_mul_f32_e64 v169, v159, v169
    v_cvt_pk_bf16_f32 v126, v162, v163
    v_cvt_pk_bf16_f32 v127, v164, v165
    s_xor_b32 s68, s0, 0xefc000
    buffer_load_dwordx4 v[252:255], v39, s[36:39], s68 offen sc1
    v_cvt_pk_bf16_f32 v128, v166, v167
    v_cvt_pk_bf16_f32 v129, v168, v169
    v_mfma_f32_32x32x16_bf16 v[58:73], v[232:235], v[182:185], v[58:73]
    ds_write_b128 v27, v[126:129] offset:5120
    s_waitcnt vmcnt(15)
    v_cvt_pk_bf16_f32 v98, v98, v99
    v_cvt_pk_bf16_f32 v99, v100, v101
    s_waitcnt vmcnt(14)
    v_cvt_pk_bf16_f32 v100, v102, v103
    v_cvt_pk_bf16_f32 v101, v104, v105
    v_mfma_f32_32x32x16_bf16 v[58:73], v[236:239], v[186:189], v[58:73]
    v_cndmask_b32 v102, v50, v98, s[58:59]
    v_cndmask_b32 v103, v51, v99, s[58:59]
    v_cndmask_b32 v104, v52, v100, s[58:59]
    v_cndmask_b32 v105, v53, v101, s[58:59]
    v_cndmask_b32 v98, v98, v50, s[58:59]
    v_cndmask_b32 v99, v99, v51, s[58:59]
    v_cndmask_b32 v100, v100, v52, s[58:59]
    v_cndmask_b32 v101, v101, v53, s[58:59]
    s_waitcnt lgkmcnt(0)
    s_barrier
    s_waitcnt vmcnt(13)
    v_mfma_f32_32x32x16_bf16 v[138:153], v[98:101], v[130:133], 0
    ds_read_b128 v[54:57], v36 offset:4096
    ds_read_b128 v[170:173], v36 offset:5120
    ds_read_b128 v[174:177], v37 offset:4096
    s_waitcnt vmcnt(12)
    v_mfma_f32_32x32x16_bf16 v[154:169], v[102:105], v[134:137], 0
    ds_read_b128 v[178:181], v37 offset:5120
    ds_read_b128 v[182:185], v38 offset:4096
    ds_read_b128 v[186:189], v38 offset:5120
    v_mfma_f32_32x32x16_bf16 v[58:73], a[208:211], v[122:125], v[58:73]
    s_nop 2
    v_add_f32 v152, s66, v152
    v_mfma_f32_32x32x16_bf16 v[58:73], a[212:215], v[126:129], v[58:73]
    v_rcp_f32 v152, v152
    s_nop 1
    v_add_f32 v161, s66, v161
    v_rcp_f32 v161, v161
    v_mul_f32 v138, v152, v138
    v_mul_f32 v139, v152, v139
    v_mul_f32 v140, v152, v140
    s_waitcnt lgkmcnt(3)
    v_mfma_f32_32x32x16_bf16 v[58:73], a[240:243], v[54:57], v[58:73]
    v_mul_f32 v141, v152, v141
    v_mul_f32 v142, v152, v142
    v_mul_f32 v143, v152, v143
    v_mul_f32 v144, v152, v144
    v_mul_f32_e64 v145, v152, v145
    v_mfma_f32_32x32x16_bf16 v[58:73], a[244:247], v[170:173], v[58:73]
    v_cvt_pk_bf16_f32 v130, v138, v139
    v_cvt_pk_bf16_f32 v131, v140, v141
    v_cvt_pk_bf16_f32 v132, v142, v143
    v_cvt_pk_bf16_f32 v133, v144, v145
    s_waitcnt vmcnt(11)
    v_mfma_f32_32x32x16_bf16 v[58:73], v[208:211], v[174:177], v[58:73]
    ds_write_b128 v27, v[130:133] offset:6144
    v_mul_f32 v162, v161, v162
    v_mul_f32 v163, v161, v163
    v_mul_f32 v164, v161, v164
    v_mul_f32 v165, v161, v165
    v_mul_f32 v166, v161, v166
    s_waitcnt lgkmcnt(1)
    s_waitcnt vmcnt(10)
    v_mfma_f32_32x32x16_bf16 v[58:73], v[212:215], v[178:181], v[58:73]
    v_mul_f32 v167, v161, v167
    v_mul_f32 v168, v161, v168
    v_mul_f32_e64 v169, v161, v169
    v_cvt_pk_bf16_f32 v134, v162, v163
    v_cvt_pk_bf16_f32 v135, v164, v165
    v_cvt_pk_bf16_f32 v136, v166, v167
    v_cvt_pk_bf16_f32 v137, v168, v169
    s_waitcnt vmcnt(9)
    v_mfma_f32_32x32x16_bf16 v[58:73], v[240:243], v[182:185], v[58:73]
    ds_write_b128 v27, v[134:137] offset:7168
    s_waitcnt vmcnt(8)
    v_mfma_f32_32x32x16_bf16 v[58:73], v[244:247], v[186:189], v[58:73]
    s_waitcnt lgkmcnt(0)
    s_barrier
    ds_read_b128 v[54:57], v36 offset:6144
    ds_read_b128 v[170:173], v36 offset:7168
    s_waitcnt vmcnt(7)
    v_mfma_f32_32x32x16_bf16 v[58:73], a[216:219], v[130:133], v[58:73]
    ds_read_b128 v[174:177], v37 offset:6144
    ds_read_b128 v[178:181], v37 offset:7168
    s_waitcnt vmcnt(6)
    v_mfma_f32_32x32x16_bf16 v[58:73], a[220:223], v[134:137], v[58:73]
    ds_read_b128 v[182:185], v38 offset:6144
    ds_read_b128 v[186:189], v38 offset:7168
    s_waitcnt vmcnt(5) lgkmcnt(5)
    v_mfma_f32_32x32x16_bf16 v[58:73], a[248:251], v[54:57], v[58:73]
    s_waitcnt vmcnt(4) lgkmcnt(4)
    v_mfma_f32_32x32x16_bf16 v[58:73], a[252:255], v[170:173], v[58:73]
    s_waitcnt vmcnt(3) lgkmcnt(3)
    v_mfma_f32_32x32x16_bf16 v[58:73], v[216:219], v[174:177], v[58:73]
    s_waitcnt vmcnt(2) lgkmcnt(2)
    v_mfma_f32_32x32x16_bf16 v[58:73], v[220:223], v[178:181], v[58:73]
    s_waitcnt vmcnt(1) lgkmcnt(1)
    v_mfma_f32_32x32x16_bf16 v[58:73], v[248:251], v[182:185], v[58:73]
    s_waitcnt vmcnt(0) lgkmcnt(0)
    v_mfma_f32_32x32x16_bf16 v[58:73], v[252:255], v[186:189], v[58:73]
    s_mov_b32 s53, 98304
    v_lshl_add_u32 v36, v0, 2, s53
    v_lshl_add_u32 v37, v1, 2, s53
    s_cmp_lg_u32 s67, 0
    s_cbranch_scc1 L_arr3
    v_mov_b32 v38, 1
    s_mov_b32 exec_hi, 0
    buffer_atomic_add v38, v32, s[36:39], 0 offen
    s_mov_b64 exec, -1
L_arr3:
    s_nop 6
    v_cvt_pk_bf16_f32 v50, v58, v59
    v_cvt_pk_bf16_f32 v51, v60, v61
    v_cvt_pk_bf16_f32 v52, v62, v63
    v_cvt_pk_bf16_f32 v53, v64, v65
    v_cvt_pk_bf16_f32 v54, v66, v67
    v_cvt_pk_bf16_f32 v55, v68, v69
    v_cvt_pk_bf16_f32 v56, v70, v71
    v_cvt_pk_bf16_f32 v57, v72, v73
    v_dot2_f32_bf16 v74, v50, s60, 0
    v_dot2_f32_bf16 v75, v50, v50, 0
    v_dot2_f32_bf16 v74, v51, s60, v74
    v_dot2_f32_bf16 v75, v51, v51, v75
    v_dot2_f32_bf16 v74, v52, s60, v74
    v_dot2_f32_bf16 v75, v52, v52, v75
    v_dot2_f32_bf16 v74, v53, s60, v74
    v_dot2_f32_bf16 v75, v53, v53, v75
    v_dot2_f32_bf16 v74, v54, s60, v74
    v_dot2_f32_bf16 v75, v54, v54, v75
    v_dot2_f32_bf16 v74, v55, s60, v74
    v_dot2_f32_bf16 v75, v55, v55, v75
    v_dot2_f32_bf16 v74, v56, s60, v74
    v_dot2_f32_bf16 v75, v56, v56, v75
    v_dot2_f32_bf16 v74, v57, s60, v74
    v_dot2_f32_bf16 v75, v57, v57, v75
    s_nop 2
    v_permlane32_swap_b32 v74, v75
    v_add_f32_e64 v74, v74, v75
    ds_write_b32 v36, v74
    s_mov_b32 s53, 0x400000
    buffer_store_dword v50, v8, s[36:39], s53 offen sc1
    s_add_u32 s53, s53, 8192
    buffer_store_dword v51, v8, s[36:39], s53 offen sc1
    s_add_u32 s53, s53, 8192
    buffer_store_dword v52, v8, s[36:39], s53 offen sc1
    s_waitcnt lgkmcnt(0)
    s_barrier
    ds_read2st64_b32 v[76:77], v37 offset0:0 offset1:1
    ds_read2st64_b32 v[78:79], v37 offset0:2 offset1:3
    s_add_u32 s53, s53, 8192
    buffer_store_dword v53, v8, s[36:39], s53 offen sc1
    s_add_u32 s53, s53, 8192
    buffer_store_dword v54, v8, s[36:39], s53 offen sc1
    s_add_u32 s53, s53, 8192
    buffer_store_dword v55, v8, s[36:39], s53 offen sc1
    s_waitcnt lgkmcnt(0)
    v_pk_add_f32 v[76:77], v[76:77], v[78:79] op_sel:[0,0] op_sel_hi:[1,1]
    v_add_f32 v74, v76, v77
    v_cmp_u_f32 vcc, v74, v74
    s_cbranch_vccnz L_slowq0
L_okq0:
    s_cmp_lg_u32 s48, 1
    s_cbranch_scc1 L_nosred
    v_mul_f32 v74, 0x3b800000, v74
    v_mul_f32 v75, 0.5, v74
    s_nop 1
    v_permlane32_swap_b32 v75, v76
    v_fma_f32 v76, -v74, v74, v76
    v_max_f32 v76, 0, v76
    v_sqrt_f32 v76, v76
    s_mov_b32 exec_hi, 0
    v_cvt_pk_bf16_f32 v74, v74, v76
    buffer_store_dword v74, v9, s[36:39], s8 offen sc1
    s_mov_b64 exec, -1
L_nosred:
    s_add_u32 s53, s53, 8192
    buffer_store_dword v56, v8, s[36:39], s53 offen sc1
    s_add_u32 s53, s53, 8192
    buffer_store_dword v57, v8, s[36:39], s53 offen sc1
    s_lshl_b32 s68, s2, 13
    s_add_u32 s68, s68, 0x400000
    s_mov_b32 s10, 0x34000
    s_mov_b32 s11, 0x36000
    s_mov_b32 s12, 0x38000
    s_mov_b32 s13, 0x3a000
    s_mov_b32 s67, s48
    s_cmp_lg_u32 s48, 0
    s_cbranch_scc1 L_ps4
    s_mov_b64 exec, 0xff
    v_mov_b32 v34, 0
    buffer_atomic_add v34, v33, s[36:39], 0 offen sc0
    s_mov_b64 exec, -1
L_ps4:
    s_branch L_pg5
.p2align 12
L_pg5:
    s_cmp_lg_u32 s48, 0
    s_cbranch_scc0 L_wait4_w0
    s_waitcnt vmcnt(0)
    s_branch L_wait4
L_wait4_w0:
    s_mov_b64 exec, 0xff
    s_movk_i32 s53, 128
    s_mov_b32 s61, 0x100000
L_wait4_poll:
    v_mov_b32 v35, 0
    buffer_atomic_add v35, v33, s[36:39], 0 offen sc0
    s_waitcnt vmcnt(1)
    v_cmp_gt_u32 vcc, s53, v34
    s_cbranch_vccz L_wait4_done
    v_mov_b32 v34, 0
    buffer_atomic_add v34, v33, s[36:39], 0 offen sc0
    s_sub_u32 s61, s61, 1
    s_cbranch_scc1 L_wait4_done
    s_waitcnt vmcnt(1)
    v_cmp_gt_u32 vcc, s53, v35
    s_cbranch_vccnz L_wait4_poll
L_wait4_done:
    s_mov_b64 exec, -1
L_wait4:
    s_barrier
    buffer_load_dwordx4 v[74:77], v10, s[36:39], s10 offen offset:0 sc1
    buffer_load_dwordx4 v[78:81], v10, s[36:39], s11 offen offset:0 sc1
    s_barrier
    buffer_load_dwordx4 v[82:85], v10, s[36:39], s12 offen offset:0 sc1
    buffer_load_dwordx4 v[86:89], v10, s[36:39], s13 offen offset:0 sc1
    buffer_load_dwordx4 v[50:53], v10, s[36:39], s68 offen offset:0 sc1
    s_barrier
    buffer_load_dwordx4 v[90:93], v10, s[36:39], s10 offen offset:1024 sc1
    buffer_load_dwordx4 v[94:97], v10, s[36:39], s11 offen offset:1024 sc1
    s_barrier
    buffer_load_dwordx4 v[98:101], v10, s[36:39], s12 offen offset:1024 sc1
    buffer_load_dwordx4 v[102:105], v10, s[36:39], s13 offen offset:1024 sc1
    buffer_load_dwordx4 v[54:57], v10, s[36:39], s68 offen offset:1024 sc1
    s_cmp_lg_u32 s67, 1
    s_cbranch_scc1 L_nofbc1
    s_mov_b32 s53, 0x2c000
    v_mov_b32 v34, 1
    s_mov_b64 exec, 1
    buffer_atomic_add v34, v32, s[36:39], s53 offen
    s_mov_b64 exec, -1
L_nofbc1:
    v_mov_b32 v36, -1
    v_mov_b32 v37, -1
    v_mov_b32 v38, -1
    v_mov_b32 v39, -1
L_redoc1:
    s_waitcnt vmcnt(9)
    v_dot2_f32_bf16 v58, v74, s9, 0
    v_dot2_f32_bf16 v59, v75, s9, 0
    v_dot2_f32_bf16 v60, v76, s9, 0
    v_dot2_f32_bf16 v61, v77, s9, 0
    v_dot2_f32_bf16 v66, v74, v74, s63
    v_dot2_f32_bf16 v67, v75, v75, s63
    v_dot2_f32_bf16 v68, v76, v76, s63
    v_dot2_f32_bf16 v69, v77, v77, s63
    s_waitcnt vmcnt(8)
    s_nop 0
    v_dot2_f32_bf16 v58, v78, s9, v58
    v_dot2_f32_bf16 v59, v79, s9, v59
    v_dot2_f32_bf16 v60, v80, s9, v60
    v_dot2_f32_bf16 v61, v81, s9, v61
    v_dot2_f32_bf16 v66, v78, v78, v66
    v_dot2_f32_bf16 v67, v79, v79, v67
    v_dot2_f32_bf16 v68, v80, v80, v68
    v_dot2_f32_bf16 v69, v81, v81, v69
    s_waitcnt vmcnt(7)
    s_nop 0
    v_dot2_f32_bf16 v58, v82, s9, v58
    v_dot2_f32_bf16 v59, v83, s9, v59
    v_dot2_f32_bf16 v60, v84, s9, v60
    v_dot2_f32_bf16 v61, v85, s9, v61
    v_dot2_f32_bf16 v66, v82, v82, v66
    v_dot2_f32_bf16 v67, v83, v83, v67
    v_dot2_f32_bf16 v68, v84, v84, v68
    v_dot2_f32_bf16 v69, v85, v85, v69
    s_waitcnt vmcnt(6)
    s_nop 0
    v_dot2_f32_bf16 v58, v86, s9, v58
    v_dot2_f32_bf16 v59, v87, s9, v59
    v_dot2_f32_bf16 v60, v88, s9, v60
    v_dot2_f32_bf16 v61, v89, s9, v61
    v_dot2_f32_bf16 v66, v86, v86, v66
    v_dot2_f32_bf16 v67, v87, v87, v67
    v_dot2_f32_bf16 v68, v88, v88, v68
    v_dot2_f32_bf16 v69, v89, v89, v69
    s_nop 0
    v_pk_fma_f32 v[66:67], v[58:59], v[58:59], v[66:67] op_sel:[0,0,0] op_sel_hi:[1,1,1] neg_lo:[1,0,0] neg_hi:[1,0,0]
    s_nop 0
    v_pk_fma_f32 v[68:69], v[60:61], v[60:61], v[68:69] op_sel:[0,0,0] op_sel_hi:[1,1,1] neg_lo:[1,0,0] neg_hi:[1,0,0]
    v_max_f32 v66, s63, v66
    v_max_f32 v67, s63, v67
    v_max_f32 v68, s63, v68
    v_max_f32 v69, s63, v69
    v_rsq_f32 v66, v66
    v_rsq_f32 v67, v67
    v_rsq_f32 v68, v68
    v_rsq_f32 v69, v69
    s_waitcnt vmcnt(5)
    v_lshlrev_b32 v106, 16, v50
    v_lshlrev_b32 v107, 16, v51
    v_lshlrev_b32 v108, 16, v52
    v_lshlrev_b32_e64 v109, 16, v53
    v_pk_add_f32 v[122:123], v[106:107], v[58:59] op_sel:[0,0] op_sel_hi:[1,1] neg_lo:[0,1] neg_hi:[0,1]
    v_pk_add_f32 v[124:125], v[108:109], v[60:61] op_sel:[0,0] op_sel_hi:[1,1] neg_lo:[0,1] neg_hi:[0,1]
    v_pk_mul_f32 v[122:123], v[122:123], v[66:67] op_sel:[0,0] op_sel_hi:[1,1]
    v_pk_mul_f32 v[124:125], v[124:125], v[68:69] op_sel:[0,0] op_sel_hi:[1,1]
    v_cvt_pk_bf16_f32 v126, v122, v123
    v_cvt_pk_bf16_f32 v127, v124, v125
    ds_write_b64 v11, v[126:127] offset:0
    v_pk_fma_f32 v[106:107], v[122:123], s[56:57], v[106:107] op_sel:[0,0,0] op_sel_hi:[1,0,1]
    v_pk_fma_f32 v[108:109], v[124:125], s[56:57], v[108:109] op_sel:[0,0,0] op_sel_hi:[1,0,1]
    v_and_b32 v110, 0xffff0000, v50
    v_and_b32 v111, 0xffff0000, v51
    v_and_b32 v112, 0xffff0000, v52
    v_and_b32 v113, 0xffff0000, v53
    v_pk_add_f32 v[122:123], v[110:111], v[58:59] op_sel:[0,0] op_sel_hi:[1,1] neg_lo:[0,1] neg_hi:[0,1]
    v_pk_add_f32 v[124:125], v[112:113], v[60:61] op_sel:[0,0] op_sel_hi:[1,1] neg_lo:[0,1] neg_hi:[0,1]
    v_pk_mul_f32 v[122:123], v[122:123], v[66:67] op_sel:[0,0] op_sel_hi:[1,1]
    v_pk_mul_f32 v[124:125], v[124:125], v[68:69] op_sel:[0,0] op_sel_hi:[1,1]
    v_cvt_pk_bf16_f32 v128, v122, v123
    v_cvt_pk_bf16_f32 v129, v124, v125
    ds_write_b64 v11, v[128:129] offset:4608
    v_pk_fma_f32 v[110:111], v[122:123], s[56:57], v[110:111] op_sel:[0,1,0] op_sel_hi:[1,1,1]
    v_pk_fma_f32 v[112:113], v[124:125], s[56:57], v[112:113] op_sel:[0,1,0] op_sel_hi:[1,1,1]
    s_waitcnt vmcnt(4)
    s_nop 0
    v_dot2_f32_bf16 v62, v90, s9, 0
    v_dot2_f32_bf16 v63, v91, s9, 0
    v_dot2_f32_bf16 v64, v92, s9, 0
    v_dot2_f32_bf16 v65, v93, s9, 0
    v_dot2_f32_bf16 v70, v90, v90, s63
    v_dot2_f32_bf16 v71, v91, v91, s63
    v_dot2_f32_bf16 v72, v92, v92, s63
    v_dot2_f32_bf16 v73, v93, v93, s63
    s_waitcnt vmcnt(3)
    s_nop 0
    v_dot2_f32_bf16 v62, v94, s9, v62
    v_dot2_f32_bf16 v63, v95, s9, v63
    v_dot2_f32_bf16 v64, v96, s9, v64
    v_dot2_f32_bf16 v65, v97, s9, v65
    v_dot2_f32_bf16 v70, v94, v94, v70
    v_dot2_f32_bf16 v71, v95, v95, v71
    v_dot2_f32_bf16 v72, v96, v96, v72
    v_dot2_f32_bf16 v73, v97, v97, v73
    s_waitcnt vmcnt(2)
    s_nop 0
    v_dot2_f32_bf16 v62, v98, s9, v62
    v_dot2_f32_bf16 v63, v99, s9, v63
    v_dot2_f32_bf16 v64, v100, s9, v64
    v_dot2_f32_bf16 v65, v101, s9, v65
    v_dot2_f32_bf16 v70, v98, v98, v70
    v_dot2_f32_bf16 v71, v99, v99, v71
    v_dot2_f32_bf16 v72, v100, v100, v72
    v_dot2_f32_bf16 v73, v101, v101, v73
    s_waitcnt vmcnt(1)
    s_nop 0
    v_dot2_f32_bf16 v62, v102, s9, v62
    v_dot2_f32_bf16 v63, v103, s9, v63
    v_dot2_f32_bf16 v64, v104, s9, v64
    v_dot2_f32_bf16 v65, v105, s9, v65
    v_dot2_f32_bf16 v70, v102, v102, v70
    v_dot2_f32_bf16 v71, v103, v103, v71
    v_dot2_f32_bf16 v72, v104, v104, v72
    v_dot2_f32_bf16 v73, v105, v105, v73
    s_nop 0
    v_pk_fma_f32 v[70:71], v[62:63], v[62:63], v[70:71] op_sel:[0,0,0] op_sel_hi:[1,1,1] neg_lo:[1,0,0] neg_hi:[1,0,0]
    s_nop 0
    v_pk_fma_f32 v[72:73], v[64:65], v[64:65], v[72:73] op_sel:[0,0,0] op_sel_hi:[1,1,1] neg_lo:[1,0,0] neg_hi:[1,0,0]
    v_max_f32 v70, s63, v70
    v_max_f32 v71, s63, v71
    v_max_f32 v72, s63, v72
    v_max_f32 v73, s63, v73
    v_rsq_f32 v70, v70
    v_rsq_f32 v71, v71
    v_rsq_f32 v72, v72
    v_rsq_f32 v73, v73
    s_waitcnt vmcnt(0)
    v_lshlrev_b32 v114, 16, v54
    v_lshlrev_b32 v115, 16, v55
    v_lshlrev_b32 v116, 16, v56
    v_lshlrev_b32_e64 v117, 16, v57
    v_pk_add_f32 v[122:123], v[114:115], v[62:63] op_sel:[0,0] op_sel_hi:[1,1] neg_lo:[0,1] neg_hi:[0,1]
    v_pk_add_f32 v[124:125], v[116:117], v[64:65] op_sel:[0,0] op_sel_hi:[1,1] neg_lo:[0,1] neg_hi:[0,1]
    v_pk_mul_f32 v[122:123], v[122:123], v[70:71] op_sel:[0,0] op_sel_hi:[1,1]
    v_pk_mul_f32 v[124:125], v[124:125], v[72:73] op_sel:[0,0] op_sel_hi:[1,1]
    v_cvt_pk_bf16_f32 v126, v122, v123
    v_cvt_pk_bf16_f32 v127, v124, v125
    ds_write_b64 v11, v[126:127] offset:512
    v_pk_fma_f32 v[114:115], v[122:123], s[56:57], v[114:115] op_sel:[0,0,0] op_sel_hi:[1,0,1]
    v_pk_fma_f32 v[116:117], v[124:125], s[56:57], v[116:117] op_sel:[0,0,0] op_sel_hi:[1,0,1]
    v_and_b32 v118, 0xffff0000, v54
    v_and_b32 v119, 0xffff0000, v55
    v_and_b32 v120, 0xffff0000, v56
    v_and_b32 v121, 0xffff0000, v57
    v_pk_add_f32 v[122:123], v[118:119], v[62:63] op_sel:[0,0] op_sel_hi:[1,1] neg_lo:[0,1] neg_hi:[0,1]
    v_pk_add_f32 v[124:125], v[120:121], v[64:65] op_sel:[0,0] op_sel_hi:[1,1] neg_lo:[0,1] neg_hi:[0,1]
    v_pk_mul_f32 v[122:123], v[122:123], v[70:71] op_sel:[0,0] op_sel_hi:[1,1]
    v_pk_mul_f32 v[124:125], v[124:125], v[72:73] op_sel:[0,0] op_sel_hi:[1,1]
    v_cvt_pk_bf16_f32 v128, v122, v123
    v_cvt_pk_bf16_f32 v129, v124, v125
    ds_write_b64 v11, v[128:129] offset:5120
    v_pk_fma_f32 v[118:119], v[122:123], s[56:57], v[118:119] op_sel:[0,1,0] op_sel_hi:[1,1,1]
    v_pk_fma_f32 v[120:121], v[124:125], s[56:57], v[120:121] op_sel:[0,1,0] op_sel_hi:[1,1,1]
    v_pk_add_f32 v[122:123], v[106:107], v[108:109] op_sel:[0,0] op_sel_hi:[1,1]
    v_pk_add_f32 v[124:125], v[114:115], v[116:117] op_sel:[0,0] op_sel_hi:[1,1]
    v_pk_add_f32 v[122:123], v[122:123], v[124:125] op_sel:[0,0] op_sel_hi:[1,1]
    v_cmp_u_f32 vcc, v122, v123
    s_cbranch_vccnz L_slowc1
L_okc1:
    s_and_b32 s53, s48, 1
    s_mul_i32 s53, s53, 768
    v_add_u32 v98, s53, v16
    v_add_u32 v99, 157440, v2
    ds_read2_b32 v[100:101], v12 offset0:176 offset1:177
    ds_read2_b32 v[102:103], v12 offset0:178 offset1:179
    ds_read2_b32 v[122:123], v12 offset0:48 offset1:49
    ds_read2_b32 v[124:125], v12 offset0:50 offset1:51
    ds_read2_b32 v[126:127], v13 offset0:176 offset1:177
    ds_read2_b32 v[128:129], v13 offset0:178 offset1:179
    ds_read2_b32 v[130:131], v13 offset0:48 offset1:49
    ds_read2_b32 v[132:133], v13 offset0:50 offset1:51
    ds_read2_b32 v[134:135], v14 offset0:176 offset1:177
    ds_read2_b32 v[136:137], v14 offset0:178 offset1:179
    s_waitcnt lgkmcnt(10)
    s_barrier
    ds_read_b128 v[138:141], v16 offset:192
    ds_read_b128 v[142:145], v16 offset:704
    ds_read_b128 v[146:149], v16 offset:1216
    ds_read_b128 v[150:153], v16 offset:1728
    s_waitcnt lgkmcnt(3)
    v_mfma_f32_16x16x32_bf16 v[50:53], v[100:103], v[138:141], 0
    ds_read_b128 v[154:157], v16 offset:2240
    v_mfma_f32_16x16x32_bf16 v[54:57], v[122:125], v[138:141], 0
    v_mfma_f32_16x16x32_bf16 v[58:61], v[126:129], v[138:141], 0
    ds_read_b128 v[158:161], v16 offset:2752
    v_mfma_f32_16x16x32_bf16 v[62:65], v[130:133], v[138:141], 0
    v_mfma_f32_16x16x32_bf16 v[66:69], v[134:137], v[138:141], 0
    s_mov_b32 s55, 0x800000
    s_waitcnt lgkmcnt(4)
    v_mfma_f32_16x16x32_bf16 v[54:57], v[100:103], v[142:145], v[54:57]
    buffer_store_dwordx2 v[36:37], v19, s[36:39], s55 offen offset:0 sc1
    v_mfma_f32_16x16x32_bf16 v[58:61], v[122:125], v[142:145], v[58:61]
    ds_read_b128 v[162:165], v16 offset:3264
    v_mfma_f32_16x16x32_bf16 v[62:65], v[126:129], v[142:145], v[62:65]
    ds_read_b128 v[166:169], v16 offset:3776
    v_mfma_f32_16x16x32_bf16 v[66:69], v[130:133], v[142:145], v[66:69]
    buffer_store_dwordx2 v[36:37], v19, s[36:39], s55 offen offset:128 sc1
    v_mfma_f32_16x16x32_bf16 v[70:73], v[134:137], v[142:145], 0
    ds_read_b128 v[170:173], v99 offset:0
    s_waitcnt lgkmcnt(6)
    v_mfma_f32_16x16x32_bf16 v[58:61], v[100:103], v[146:149], v[58:61]
    ds_read_b128 v[138:141], v98 offset:176
    s_nop 0
    s_mov_b32 s55, 0x840000
    v_mfma_f32_16x16x32_bf16 v[62:65], v[122:125], v[146:149], v[62:65]
    buffer_store_dwordx2 v[36:37], v19, s[36:39], s55 offen offset:0 sc1
    v_mfma_f32_16x16x32_bf16 v[66:69], v[126:129], v[146:149], v[66:69]
    ds_read_b128 v[142:145], v99 offset:1024
    v_mfma_f32_16x16x32_bf16 v[70:73], v[130:133], v[146:149], v[70:73]
    v_mfma_f32_16x16x32_bf16 v[74:77], v[134:137], v[146:149], 0
    buffer_store_dwordx2 v[36:37], v19, s[36:39], s55 offen offset:128 sc1
    s_waitcnt lgkmcnt(7)
    v_mfma_f32_16x16x32_bf16 v[62:65], v[100:103], v[150:153], v[62:65]
    ds_read_b128 v[146:149], v98 offset:192
    v_mfma_f32_16x16x32_bf16 v[66:69], v[122:125], v[150:153], v[66:69]
    s_lshl4_add_u32 s54, s49, s50
    v_mfma_f32_16x16x32_bf16 v[70:73], v[126:129], v[150:153], v[70:73]
    s_lshl2_add_u32 s54, s54, s48
    v_mfma_f32_16x16x32_bf16 v[74:77], v[130:133], v[150:153], v[74:77]
    s_lshl_b32 s54, s54, 10
    v_mfma_f32_16x16x32_bf16 v[78:81], v[134:137], v[150:153], 0
    ds_read_b128 v[134:137], v98 offset:1200
    s_add_u32 s54, s54, 0xc00000
    s_waitcnt lgkmcnt(8)
    v_mfma_f32_16x16x32_bf16 v[66:69], v[100:103], v[154:157], v[66:69]
    s_nop 0
    buffer_store_dwordx4 v[36:39], v2, s[36:39], s54 offen sc1
    v_mfma_f32_16x16x32_bf16 v[70:73], v[122:125], v[154:157], v[70:73]
    ds_read_b128 v[150:153], v98 offset:1216
    v_mfma_f32_16x16x32_bf16 v[74:77], v[126:129], v[154:157], v[74:77]
    v_mfma_f32_16x16x32_bf16 v[78:81], v[130:133], v[154:157], v[78:81]
    ds_read2_b32 v[130:131], v12 offset0:160 offset1:161
    s_waitcnt lgkmcnt(9)
    v_mfma_f32_16x16x32_bf16 v[70:73], v[100:103], v[158:161], v[70:73]
    ds_read2_b32 v[132:133], v12 offset0:162 offset1:163
    s_add_u32 s54, s54, 0x8000
    v_mfma_f32_16x16x32_bf16 v[74:77], v[122:125], v[158:161], v[74:77]
    buffer_store_dwordx4 v[36:39], v2, s[36:39], s54 offen sc1
    v_mfma_f32_16x16x32_bf16 v[78:81], v[126:129], v[158:161], v[78:81]
    ds_read_b128 v[154:157], v16 offset:128
    s_waitcnt lgkmcnt(10)
    v_mfma_f32_16x16x32_bf16 v[74:77], v[100:103], v[162:165], v[74:77]
    ds_read2_b32 v[126:127], v12 offset0:32 offset1:33
    v_mfma_f32_16x16x32_bf16 v[78:81], v[122:125], v[162:165], v[78:81]
    ds_read2_b32 v[128:129], v12 offset0:34 offset1:35
    s_waitcnt lgkmcnt(11)
    v_mfma_f32_16x16x32_bf16 v[78:81], v[100:103], v[166:169], v[78:81]
    ds_read2_b32 v[158:159], v13 offset0:160 offset1:161
    s_waitcnt lgkmcnt(10)
    v_mfma_f32_16x16x32_bf16 v[82:85], v[138:141], v[170:173], 0
    ds_read2_b32 v[160:161], v13 offset0:162 offset1:163
    s_waitcnt lgkmcnt(9)
    v_mfma_f32_16x16x32_bf16 v[86:89], v[146:149], v[142:145], 0
    ds_read2_b32 v[122:123], v13 offset0:32 offset1:33
    s_waitcnt lgkmcnt(9)
    v_mfma_f32_16x16x32_bf16 v[90:93], v[134:137], v[170:173], 0
    ds_read2_b32 v[124:125], v13 offset0:34 offset1:35
    s_waitcnt lgkmcnt(9)
    v_mfma_f32_16x16x32_bf16 v[94:97], v[150:153], v[142:145], 0
    ds_read_b128 v[162:165], v16 offset:640
    s_waitcnt lgkmcnt(7)
    v_mfma_f32_16x16x32_bf16 v[50:53], v[130:133], v[154:157], v[50:53]
    ds_read_b128 v[100:103], v16 offset:1152
    s_waitcnt lgkmcnt(6)
    v_mfma_f32_16x16x32_bf16 v[54:57], v[126:129], v[154:157], v[54:57]
    ds_read_b128 v[166:169], v16 offset:1664
    s_waitcnt lgkmcnt(5)
    v_mfma_f32_16x16x32_bf16 v[58:61], v[158:161], v[154:157], v[58:61]
    ds_read_b128 v[138:141], v16 offset:2176
    s_waitcnt lgkmcnt(4)
    v_mfma_f32_16x16x32_bf16 v[62:65], v[122:125], v[154:157], v[62:65]
    ds_read_b128 v[146:149], v16 offset:2688
    s_waitcnt lgkmcnt(4)
    v_mfma_f32_16x16x32_bf16 v[54:57], v[130:133], v[162:165], v[54:57]
    ds_read_b128 v[170:173], v16 offset:3200
    v_mfma_f32_16x16x32_bf16 v[58:61], v[126:129], v[162:165], v[58:61]
    ds_read_b128 v[134:137], v16 offset:3712
    v_mfma_f32_16x16x32_bf16 v[62:65], v[158:161], v[162:165], v[62:65]
    ds_read2_b32 v[142:143], v15 offset0:48 offset1:49
    v_cvt_pk_bf16_f32 v82, v82, v86
    v_mfma_f32_16x16x32_bf16 v[66:69], v[122:125], v[162:165], v[66:69]
    ds_read2_b32 v[144:145], v15 offset0:50 offset1:51
    v_cvt_pk_bf16_f32 v83, v83, v87
    s_waitcnt lgkmcnt(7)
    v_mfma_f32_16x16x32_bf16 v[58:61], v[130:133], v[100:103], v[58:61]
    ds_read2_b32 v[150:151], v15 offset0:32 offset1:33
    s_nop 0
    v_cvt_pk_bf16_f32 v84, v84, v88
    v_mfma_f32_16x16x32_bf16 v[62:65], v[126:129], v[100:103], v[62:65]
    ds_read2_b32 v[152:153], v15 offset0:34 offset1:35
    v_cvt_pk_bf16_f32 v85, v85, v89
    v_mfma_f32_16x16x32_bf16 v[66:69], v[158:161], v[100:103], v[66:69]
    ds_read2_b32 v[154:155], v15 offset0:16 offset1:17
    v_cvt_pk_bf16_f32 v90, v90, v94
    v_mfma_f32_16x16x32_bf16 v[70:73], v[122:125], v[100:103], v[70:73]
    ds_read2_b32 v[156:157], v15 offset0:18 offset1:19
    v_cvt_pk_bf16_f32 v91, v91, v95
    s_waitcnt lgkmcnt(10)
    v_mfma_f32_16x16x32_bf16 v[62:65], v[130:133], v[166:169], v[62:65]
    ds_read2_b32 v[162:163], v15 offset0:0 offset1:1
    s_nop 0
    v_cvt_pk_bf16_f32 v92, v92, v96
    v_mfma_f32_16x16x32_bf16 v[66:69], v[126:129], v[166:169], v[66:69]
    ds_read2_b32 v[164:165], v15 offset0:2 offset1:3
    v_cvt_pk_bf16_f32 v93, v93, v97
    v_mfma_f32_16x16x32_bf16 v[70:73], v[158:161], v[166:169], v[70:73]
    ds_read2_b32 v[100:101], v12 offset0:144 offset1:145
    v_mfma_f32_16x16x32_bf16 v[74:77], v[122:125], v[166:169], v[74:77]
    ds_read2_b32 v[102:103], v12 offset0:146 offset1:147
    s_waitcnt lgkmcnt(13)
    v_mfma_f32_16x16x32_bf16 v[66:69], v[130:133], v[138:141], v[66:69]
    ds_read_b128 v[166:169], v16 offset:64
    v_mfma_f32_16x16x32_bf16 v[70:73], v[126:129], v[138:141], v[70:73]
    v_mfma_f32_16x16x32_bf16 v[74:77], v[158:161], v[138:141], v[74:77]
    v_mfma_f32_16x16x32_bf16 v[78:81], v[122:125], v[138:141], v[78:81]
    ds_read2_b32 v[122:123], v12 offset0:16 offset1:17
    s_waitcnt lgkmcnt(14)
    v_mfma_f32_16x16x32_bf16 v[70:73], v[130:133], v[146:149], v[70:73]
    ds_read2_b32 v[124:125], v12 offset0:18 offset1:19
    v_mfma_f32_16x16x32_bf16 v[74:77], v[126:129], v[146:149], v[74:77]
    ds_read2_b32 v[138:139], v13 offset0:144 offset1:145
    v_mfma_f32_16x16x32_bf16 v[78:81], v[158:161], v[146:149], v[78:81]
    ds_read2_b32 v[140:141], v13 offset0:146 offset1:147
    s_waitcnt lgkmcnt(15)
    v_mfma_f32_16x16x32_bf16 v[74:77], v[130:133], v[170:173], v[74:77]
    ds_read2_b32 v[158:159], v13 offset0:16 offset1:17
    v_mfma_f32_16x16x32_bf16 v[78:81], v[126:129], v[170:173], v[78:81]
    ds_read2_b32 v[160:161], v13 offset0:18 offset1:19
    v_mfma_f32_16x16x32_bf16 v[78:81], v[130:133], v[134:137], v[78:81]
    ds_read_b128 v[146:149], v16 offset:576
    s_waitcnt lgkmcnt(15)
    v_mfma_f32_16x16x32_bf16 v[66:69], v[82:85], v[142:145], v[66:69]
    ds_read_b128 v[126:129], v16 offset:1088
    v_mfma_f32_16x16x32_bf16 v[74:77], v[90:93], v[142:145], v[74:77]
    ds_read_b128 v[170:173], v16 offset:1600
    s_waitcnt lgkmcnt(15)
    v_mfma_f32_16x16x32_bf16 v[70:73], v[82:85], v[150:153], v[70:73]
    ds_read_b128 v[130:133], v16 offset:2112
    v_mfma_f32_16x16x32_bf16 v[78:81], v[90:93], v[150:153], v[78:81]
    s_waitcnt lgkmcnt(15)
    v_mfma_f32_16x16x32_bf16 v[74:77], v[82:85], v[154:157], v[74:77]
    ds_read_b128 v[134:137], v16 offset:2624
    s_waitcnt lgkmcnt(14)
    v_mfma_f32_16x16x32_bf16 v[78:81], v[82:85], v[162:165], v[78:81]
    s_waitcnt lgkmcnt(11)
    v_mfma_f32_16x16x32_bf16 v[50:53], v[100:103], v[166:169], v[50:53]
    s_waitcnt lgkmcnt(9)
    v_mfma_f32_16x16x32_bf16 v[54:57], v[122:125], v[166:169], v[54:57]
    ds_read_b128 v[142:145], v16 offset:3136
    s_waitcnt lgkmcnt(8)
    v_mfma_f32_16x16x32_bf16 v[58:61], v[138:141], v[166:169], v[58:61]
    s_waitcnt lgkmcnt(6)
    v_mfma_f32_16x16x32_bf16 v[62:65], v[158:161], v[166:169], v[62:65]
    ds_read_b128 v[150:153], v16 offset:3648
    s_waitcnt lgkmcnt(6)
    v_mfma_f32_16x16x32_bf16 v[54:57], v[100:103], v[146:149], v[54:57]
    ds_read2_b32 v[154:155], v12 offset0:128 offset1:129
    v_mfma_f32_16x16x32_bf16 v[58:61], v[122:125], v[146:149], v[58:61]
    ds_read2_b32 v[156:157], v12 offset0:130 offset1:131
    v_mfma_f32_16x16x32_bf16 v[62:65], v[138:141], v[146:149], v[62:65]
    ds_read_b128 v[162:165], v16 offset:0
    v_mfma_f32_16x16x32_bf16 v[66:69], v[158:161], v[146:149], v[66:69]
    ds_read2_b32 v[166:167], v12 offset0:0 offset1:1
    s_waitcnt lgkmcnt(9)
    v_mfma_f32_16x16x32_bf16 v[58:61], v[100:103], v[126:129], v[58:61]
    ds_read2_b32 v[168:169], v12 offset0:2 offset1:3
    v_mfma_f32_16x16x32_bf16 v[62:65], v[122:125], v[126:129], v[62:65]
    ds_read_b128 v[146:149], v16 offset:512
    v_mfma_f32_16x16x32_bf16 v[66:69], v[138:141], v[126:129], v[66:69]
    v_mfma_f32_16x16x32_bf16 v[70:73], v[158:161], v[126:129], v[70:73]
    ds_read2_b32 v[126:127], v13 offset0:128 offset1:129
    s_waitcnt lgkmcnt(11)
    v_mfma_f32_16x16x32_bf16 v[62:65], v[100:103], v[170:173], v[62:65]
    ds_read2_b32 v[128:129], v13 offset0:130 offset1:131
    v_mfma_f32_16x16x32_bf16 v[66:69], v[122:125], v[170:173], v[66:69]
    v_mfma_f32_16x16x32_bf16 v[70:73], v[138:141], v[170:173], v[70:73]
    v_mfma_f32_16x16x32_bf16 v[74:77], v[158:161], v[170:173], v[74:77]
    ds_read_b128 v[170:173], v16 offset:1024
    s_waitcnt lgkmcnt(12)
    v_mfma_f32_16x16x32_bf16 v[66:69], v[100:103], v[130:133], v[66:69]
    v_mfma_f32_16x16x32_bf16 v[70:73], v[122:125], v[130:133], v[70:73]
    v_mfma_f32_16x16x32_bf16 v[74:77], v[138:141], v[130:133], v[74:77]
    v_mfma_f32_16x16x32_bf16 v[78:81], v[158:161], v[130:133], v[78:81]
    ds_read2_b32 v[158:159], v13 offset0:0 offset1:1
    s_waitcnt lgkmcnt(12)
    v_mfma_f32_16x16x32_bf16 v[70:73], v[100:103], v[134:137], v[70:73]
    ds_read2_b32 v[160:161], v13 offset0:2 offset1:3
    v_mfma_f32_16x16x32_bf16 v[74:77], v[122:125], v[134:137], v[74:77]
    ds_read_b128 v[130:133], v16 offset:1536
    v_mfma_f32_16x16x32_bf16 v[78:81], v[138:141], v[134:137], v[78:81]
    ds_read_b128 v[138:141], v16 offset:2048
    s_waitcnt lgkmcnt(14)
    v_mfma_f32_16x16x32_bf16 v[74:77], v[100:103], v[142:145], v[74:77]
    ds_read_b128 v[134:137], v16 offset:2560
    v_mfma_f32_16x16x32_bf16 v[78:81], v[122:125], v[142:145], v[78:81]
    s_waitcnt lgkmcnt(14)
    v_mfma_f32_16x16x32_bf16 v[78:81], v[100:103], v[150:153], v[78:81]
    ds_read_b128 v[122:125], v16 offset:3072
    s_waitcnt lgkmcnt(12)
    v_mfma_f32_16x16x32_bf16 v[50:53], v[154:157], v[162:165], v[50:53]
    s_waitcnt lgkmcnt(10)
    v_mfma_f32_16x16x32_bf16 v[54:57], v[166:169], v[162:165], v[54:57]
    s_waitcnt lgkmcnt(9)
    v_mfma_f32_16x16x32_bf16 v[54:57], v[154:157], v[146:149], v[54:57]
    s_waitcnt lgkmcnt(7)
    v_mfma_f32_16x16x32_bf16 v[58:61], v[126:129], v[162:165], v[58:61]
    ds_read_b128 v[142:145], v16 offset:3584
    v_mfma_f32_16x16x32_bf16 v[58:61], v[166:169], v[146:149], v[58:61]
    s_waitcnt lgkmcnt(7)
    v_mfma_f32_16x16x32_bf16 v[58:61], v[154:157], v[170:173], v[58:61]
    ds_write_b128 v17, v[50:53] offset:0
    s_waitcnt lgkmcnt(6)
    v_mfma_f32_16x16x32_bf16 v[62:65], v[158:161], v[162:165], v[62:65]
    v_mfma_f32_16x16x32_bf16 v[62:65], v[126:129], v[146:149], v[62:65]
    ds_write_b128 v17, v[54:57] offset:1280
    v_mfma_f32_16x16x32_bf16 v[62:65], v[166:169], v[170:173], v[62:65]
    s_waitcnt lgkmcnt(6)
    v_mfma_f32_16x16x32_bf16 v[62:65], v[154:157], v[130:133], v[62:65]
    v_mfma_f32_16x16x32_bf16 v[66:69], v[158:161], v[146:149], v[66:69]
    ds_write_b128 v17, v[58:61] offset:2560
    v_mfma_f32_16x16x32_bf16 v[66:69], v[126:129], v[170:173], v[66:69]
    v_mfma_f32_16x16x32_bf16 v[66:69], v[166:169], v[130:133], v[66:69]
    s_waitcnt lgkmcnt(6)
    v_mfma_f32_16x16x32_bf16 v[66:69], v[154:157], v[138:141], v[66:69]
    v_mfma_f32_16x16x32_bf16 v[70:73], v[158:161], v[170:173], v[70:73]
    s_nop 0
    ds_write_b128 v17, v[62:65] offset:3840
    v_mfma_f32_16x16x32_bf16 v[70:73], v[126:129], v[130:133], v[70:73]
    v_mfma_f32_16x16x32_bf16 v[70:73], v[166:169], v[138:141], v[70:73]
    s_waitcnt lgkmcnt(6)
    v_mfma_f32_16x16x32_bf16 v[70:73], v[154:157], v[134:137], v[70:73]
    v_mfma_f32_16x16x32_bf16 v[74:77], v[158:161], v[130:133], v[74:77]
    ds_write_b128 v17, v[66:69] offset:5120
    v_mfma_f32_16x16x32_bf16 v[74:77], v[126:129], v[138:141], v[74:77]
    v_mfma_f32_16x16x32_bf16 v[74:77], v[166:169], v[134:137], v[74:77]
    s_waitcnt lgkmcnt(6)
    v_mfma_f32_16x16x32_bf16 v[74:77], v[154:157], v[122:125], v[74:77]
    v_mfma_f32_16x16x32_bf16 v[78:81], v[158:161], v[138:141], v[78:81]
    s_nop 0
    ds_write_b128 v17, v[70:73] offset:6400
    v_mfma_f32_16x16x32_bf16 v[78:81], v[126:129], v[134:137], v[78:81]
    v_mfma_f32_16x16x32_bf16 v[78:81], v[166:169], v[122:125], v[78:81]
    s_waitcnt lgkmcnt(6)
    v_mfma_f32_16x16x32_bf16 v[78:81], v[154:157], v[142:145], v[78:81]
    s_nop 0
    ds_write_b128 v17, v[74:77] offset:7680
    s_nop 5
    ds_write_b128 v17, v[78:81] offset:8960
    s_waitcnt vmcnt(2)
    s_waitcnt lgkmcnt(0)
    s_barrier
    ds_read_b128 v[50:53], v18 offset:0
    ds_read_b128 v[54:57], v18 offset:10240
    ds_read_b128 v[58:61], v18 offset:20480
    ds_read_b128 v[62:65], v18 offset:30720
    ds_read_b128 v[66:69], v18 offset:1280
    ds_read_b128 v[70:73], v18 offset:11520
    ds_read_b128 v[74:77], v18 offset:21760
    ds_read_b128 v[78:81], v18 offset:32000
    s_cmp_lg_u32 s48, 0
    s_cbranch_scc1 L_arr4
    v_mov_b32 v36, 1
    s_mov_b32 exec_hi, 0
    buffer_atomic_add v36, v32, s[36:39], 0 offen
    s_mov_b64 exec, -1
L_arr4:
    s_mov_b32 s53, 0x800000
    s_mov_b32 s54, 0x840000
    s_waitcnt lgkmcnt(7)
    v_pk_add_f32 v[106:107], v[106:107], v[50:51] op_sel:[0,0] op_sel_hi:[1,1]
    v_pk_add_f32 v[108:109], v[108:109], v[52:53] op_sel:[0,0] op_sel_hi:[1,1]
    s_waitcnt lgkmcnt(6)
    v_pk_add_f32 v[106:107], v[106:107], v[54:55] op_sel:[0,0] op_sel_hi:[1,1]
    v_pk_add_f32 v[108:109], v[108:109], v[56:57] op_sel:[0,0] op_sel_hi:[1,1]
    v_cvt_pk_bf16_f32 v50, v106, v107
    v_cvt_pk_bf16_f32 v51, v108, v109
    buffer_store_dwordx2 v[50:51], v19, s[36:39], s53 offen offset:0 sc1
    s_waitcnt lgkmcnt(5)
    v_pk_add_f32 v[110:111], v[110:111], v[58:59] op_sel:[0,0] op_sel_hi:[1,1]
    v_pk_add_f32 v[112:113], v[112:113], v[60:61] op_sel:[0,0] op_sel_hi:[1,1]
    s_waitcnt lgkmcnt(4)
    v_pk_add_f32 v[110:111], v[110:111], v[62:63] op_sel:[0,0] op_sel_hi:[1,1]
    v_pk_add_f32 v[112:113], v[112:113], v[64:65] op_sel:[0,0] op_sel_hi:[1,1]
    v_cvt_pk_bf16_f32 v58, v110, v111
    v_cvt_pk_bf16_f32 v59, v112, v113
    buffer_store_dwordx2 v[58:59], v19, s[36:39], s53 offen offset:128 sc1
    s_waitcnt lgkmcnt(3)
    v_pk_add_f32 v[114:115], v[114:115], v[66:67] op_sel:[0,0] op_sel_hi:[1,1]
    v_pk_add_f32 v[116:117], v[116:117], v[68:69] op_sel:[0,0] op_sel_hi:[1,1]
    s_waitcnt lgkmcnt(2)
    v_pk_add_f32 v[114:115], v[114:115], v[70:71] op_sel:[0,0] op_sel_hi:[1,1]
    v_pk_add_f32 v[116:117], v[116:117], v[72:73] op_sel:[0,0] op_sel_hi:[1,1]
    v_cvt_pk_bf16_f32 v66, v114, v115
    v_cvt_pk_bf16_f32 v67, v116, v117
    buffer_store_dwordx2 v[66:67], v19, s[36:39], s54 offen offset:0 sc1
    s_waitcnt lgkmcnt(1)
    v_pk_add_f32 v[118:119], v[118:119], v[74:75] op_sel:[0,0] op_sel_hi:[1,1]
    v_pk_add_f32 v[120:121], v[120:121], v[76:77] op_sel:[0,0] op_sel_hi:[1,1]
    s_waitcnt lgkmcnt(0)
    v_pk_add_f32 v[118:119], v[118:119], v[78:79] op_sel:[0,0] op_sel_hi:[1,1]
    v_pk_add_f32 v[120:121], v[120:121], v[80:81] op_sel:[0,0] op_sel_hi:[1,1]
    v_cvt_pk_bf16_f32 v74, v118, v119
    v_cvt_pk_bf16_f32 v75, v120, v121
    buffer_store_dwordx2 v[74:75], v19, s[36:39], s54 offen offset:128 sc1
    s_cmp_lg_u32 s48, 0
    s_cbranch_scc1 L_ps5
    s_mov_b64 exec, 0xff
    v_mov_b32 v34, 0
    buffer_atomic_add v34, v33, s[36:39], 0 offen sc0
    s_mov_b64 exec, -1
L_ps5:
    s_mov_b32 s67, s48
    s_branch L_pg6
.p2align 12
L_pg6:
    s_cmp_lg_u32 s48, 0
    s_cbranch_scc0 L_wait5_w0
    s_mov_b64 exec, 0
    s_branch L_stub_s5_0
L_tback_s5:
    s_mov_b64 exec, -1
    s_nop 0
    s_branch L_wait5
L_wait5_w0:
    s_mov_b64 exec, 0xff
    s_movk_i32 s53, 160
    s_mov_b32 s61, 0x100000
L_wait5_poll:
    v_mov_b32_e64 v35, 0
    buffer_atomic_add v35, v33, s[36:39], 0 offen sc0
    s_waitcnt vmcnt(1)
    v_cmp_gt_u32 vcc, s53, v34
    s_cbranch_vccz L_wait5_done
    v_mov_b32 v34, 0
    buffer_atomic_add v34, v33, s[36:39], 0 offen sc0
    s_sub_u32 s61, s61, 1
    s_cbranch_scc1 L_wait5_done
    s_waitcnt vmcnt(1)
    v_cmp_gt_u32 vcc, s53, v35
    s_cbranch_vccnz L_wait5_poll
L_wait5_done:
    s_mov_b64 exec, -1
L_wait5:
    s_barrier
L_redox1:
    s_lshl_b32 m0, s48, 10
    s_sub_u32 s69, 0x800000, s5
    buffer_load_dwordx4 v20, s[36:39], s69 offen offset:0 sc1 lds
    s_barrier
    s_add_u32 m0, m0, 4096
    s_add_u32 s69, s69, 4096
    buffer_load_dwordx4 v20, s[36:39], s69 offen offset:0 sc1 lds
    s_barrier
    s_add_u32 m0, m0, 4096
    s_add_u32 s69, s69, 4096
    buffer_load_dwordx4 v20, s[36:39], s69 offen offset:0 sc1 lds
    s_add_u32 m0, m0, 4096
    s_add_u32 s69, s69, 4096
    buffer_load_dwordx4 v20, s[36:39], s69 offen offset:0 sc1 lds
    s_barrier
    s_nop 0
    s_add_u32 m0, s4, 16384
    s_mov_b32 s69, 0x804000
    buffer_load_dwordx4 v20, s[36:39], s69 offen offset:0 sc1 lds
    buffer_load_dwordx4 v20, s[36:39], s69 offen offset:1024 sc1 lds
    buffer_load_dwordx4 v20, s[36:39], s69 offen offset:2048 sc1 lds
    buffer_load_dwordx4 v20, s[36:39], s69 offen offset:3072 sc1 lds
    s_waitcnt vmcnt(7)
    s_barrier
    ds_read_b64_tr_b16 v[36:37], v3 offset:0
    ds_read_b64_tr_b16 v[38:39], v3 offset:2048
    ds_read_b64_tr_b16 v[138:139], v4 offset:0
    ds_read_b64_tr_b16 v[140:141], v4 offset:2048
    ds_read_b64_tr_b16 v[142:143], v5 offset:0
    ds_read_b64_tr_b16 v[144:145], v5 offset:2048
    ds_read_b64_tr_b16 v[146:147], v6 offset:0
    ds_read_b64_tr_b16 v[148:149], v6 offset:2048
    s_waitcnt lgkmcnt(6)
    v_mfma_f32_16x16x32_bf16 v[84:87], v[36:39], v[36:39], 0
    s_waitcnt vmcnt(6)
    s_barrier
    ds_read_b64_tr_b16 v[150:151], v3 offset:4096
    s_nop 0
    s_add_u32 m0, s4, 32768
    v_mfma_f32_16x16x32_bf16 v[88:91], v[46:49], v[36:39], 0
    ds_read_b64_tr_b16 v[152:153], v3 offset:6144
    s_mov_b32 s69, 0x808000
    v_mfma_f32_16x16x32_bf16 v[52:55], v[36:39], a[64:67], 0
    buffer_load_dwordx4 v20, s[36:39], s69 offen offset:0 sc1 lds
    v_mfma_f32_16x16x32_bf16 v[68:71], v[36:39], a[128:131], 0
    ds_read_b64_tr_b16 v[154:155], v4 offset:4096
    s_waitcnt lgkmcnt(7)
    v_mfma_f32_16x16x32_bf16 v[56:59], v[138:141], a[64:67], 0
    ds_read_b64_tr_b16 v[156:157], v4 offset:6144
    v_mfma_f32_16x16x32_bf16 v[72:75], v[138:141], a[128:131], 0
    buffer_load_dwordx4 v20, s[36:39], s69 offen offset:1024 sc1 lds
    s_waitcnt lgkmcnt(6)
    v_mfma_f32_16x16x32_bf16 v[60:63], v[142:145], a[64:67], 0
    ds_read_b64_tr_b16 v[158:159], v5 offset:4096
    v_mfma_f32_16x16x32_bf16 v[76:79], v[142:145], a[128:131], 0
    ds_read_b64_tr_b16 v[160:161], v5 offset:6144
    s_waitcnt lgkmcnt(6)
    v_mfma_f32_16x16x32_bf16 v[64:67], v[146:149], a[64:67], 0
    buffer_load_dwordx4 v20, s[36:39], s69 offen offset:2048 sc1 lds
    v_mfma_f32_16x16x32_bf16 v[80:83], v[146:149], a[128:131], 0
    ds_read_b64_tr_b16 v[162:163], v6 offset:4096
    s_waitcnt lgkmcnt(5)
    v_mfma_f32_16x16x32_bf16 v[84:87], v[150:153], v[150:153], v[84:87]
    ds_read_b64_tr_b16 v[164:165], v6 offset:6144
    v_mfma_f32_16x16x32_bf16 v[88:91], v[46:49], v[150:153], v[88:91]
    buffer_load_dwordx4 v20, s[36:39], s69 offen offset:3072 sc1 lds
    v_mfma_f32_16x16x32_bf16 v[52:55], v[150:153], a[68:71], v[52:55]
    s_waitcnt vmcnt(9)
    s_barrier
    ds_read_b64_tr_b16 v[166:167], v3 offset:8192
    s_add_u32 m0, s4, 49152
    v_mfma_f32_16x16x32_bf16 v[68:71], v[150:153], a[132:135], v[68:71]
    ds_read_b64_tr_b16 v[168:169], v3 offset:10240
    s_mov_b32 s69, 0x80c000
    s_waitcnt lgkmcnt(6)
    v_mfma_f32_16x16x32_bf16 v[56:59], v[154:157], a[68:71], v[56:59]
    buffer_load_dwordx4 v20, s[36:39], s69 offen offset:0 sc1 lds
    v_mfma_f32_16x16x32_bf16 v[72:75], v[154:157], a[132:135], v[72:75]
    ds_read_b64_tr_b16 v[36:37], v4 offset:8192
    s_waitcnt lgkmcnt(5)
    v_mfma_f32_16x16x32_bf16 v[60:63], v[158:161], a[68:71], v[60:63]
    ds_read_b64_tr_b16 v[38:39], v4 offset:10240
    v_mfma_f32_16x16x32_bf16 v[76:79], v[158:161], a[132:135], v[76:79]
    buffer_load_dwordx4 v20, s[36:39], s69 offen offset:1024 sc1 lds
    s_waitcnt lgkmcnt(4)
    v_mfma_f32_16x16x32_bf16 v[64:67], v[162:165], a[68:71], v[64:67]
    ds_read_b64_tr_b16 v[138:139], v5 offset:8192
    v_mfma_f32_16x16x32_bf16 v[80:83], v[162:165], a[132:135], v[80:83]
    ds_read_b64_tr_b16 v[140:141], v5 offset:10240
    s_waitcnt lgkmcnt(4)
    v_mfma_f32_16x16x32_bf16 v[84:87], v[166:169], v[166:169], v[84:87]
    buffer_load_dwordx4 v20, s[36:39], s69 offen offset:2048 sc1 lds
    v_mfma_f32_16x16x32_bf16 v[88:91], v[46:49], v[166:169], v[88:91]
    ds_read_b64_tr_b16 v[142:143], v6 offset:8192
    v_mfma_f32_16x16x32_bf16 v[52:55], v[166:169], a[72:75], v[52:55]
    ds_read_b64_tr_b16 v[144:145], v6 offset:10240
    v_mfma_f32_16x16x32_bf16 v[68:71], v[166:169], a[136:139], v[68:71]
    buffer_load_dwordx4 v20, s[36:39], s69 offen offset:3072 sc1 lds
    s_waitcnt lgkmcnt(4)
    v_mfma_f32_16x16x32_bf16 v[56:59], v[36:39], a[72:75], v[56:59]
    s_waitcnt vmcnt(12)
    s_barrier
    ds_read_b64_tr_b16 v[146:147], v3 offset:12288
    v_mfma_f32_16x16x32_bf16 v[72:75], v[36:39], a[136:139], v[72:75]
    ds_read_b64_tr_b16 v[148:149], v3 offset:14336
    s_waitcnt lgkmcnt(4)
    v_mfma_f32_16x16x32_bf16 v[60:63], v[138:141], a[72:75], v[60:63]
    ds_read_b64_tr_b16 v[150:151], v4 offset:12288
    v_mfma_f32_16x16x32_bf16 v[76:79], v[138:141], a[136:139], v[76:79]
    ds_read_b64_tr_b16 v[152:153], v4 offset:14336
    s_waitcnt lgkmcnt(4)
    v_mfma_f32_16x16x32_bf16 v[64:67], v[142:145], a[72:75], v[64:67]
    ds_read_b64_tr_b16 v[154:155], v5 offset:12288
    v_mfma_f32_16x16x32_bf16 v[80:83], v[142:145], a[136:139], v[80:83]
    ds_read_b64_tr_b16 v[156:157], v5 offset:14336
    s_waitcnt lgkmcnt(4)
    v_mfma_f32_16x16x32_bf16 v[84:87], v[146:149], v[146:149], v[84:87]
    ds_read_b64_tr_b16 v[158:159], v6 offset:12288
    v_mfma_f32_16x16x32_bf16 v[88:91], v[46:49], v[146:149], v[88:91]
    ds_read_b64_tr_b16 v[160:161], v6 offset:14336
    v_mfma_f32_16x16x32_bf16 v[52:55], v[146:149], a[76:79], v[52:55]
    s_waitcnt vmcnt(8)
    s_barrier
    ds_read_b64_tr_b16 v[162:163], v3 offset:16384
    v_mfma_f32_16x16x32_bf16 v[68:71], v[146:149], a[140:143], v[68:71]
    ds_read_b64_tr_b16 v[164:165], v3 offset:18432
    s_waitcnt lgkmcnt(6)
    v_mfma_f32_16x16x32_bf16 v[56:59], v[150:153], a[76:79], v[56:59]
    ds_read_b64_tr_b16 v[166:167], v4 offset:16384
    v_mfma_f32_16x16x32_bf16 v[72:75], v[150:153], a[140:143], v[72:75]
    ds_read_b64_tr_b16 v[168:169], v4 offset:18432
    s_waitcnt lgkmcnt(6)
    v_mfma_f32_16x16x32_bf16 v[60:63], v[154:157], a[76:79], v[60:63]
    ds_read_b64_tr_b16 v[36:37], v5 offset:16384
    v_mfma_f32_16x16x32_bf16 v[76:79], v[154:157], a[140:143], v[76:79]
    ds_read_b64_tr_b16 v[38:39], v5 offset:18432
    s_waitcnt lgkmcnt(6)
    v_mfma_f32_16x16x32_bf16 v[64:67], v[158:161], a[76:79], v[64:67]
    ds_read_b64_tr_b16 v[138:139], v6 offset:16384
    v_mfma_f32_16x16x32_bf16 v[80:83], v[158:161], a[140:143], v[80:83]
    ds_read_b64_tr_b16 v[140:141], v6 offset:18432
    s_waitcnt lgkmcnt(6)
    v_mfma_f32_16x16x32_bf16 v[84:87], v[162:165], v[162:165], v[84:87]
    ds_read_b64_tr_b16 v[142:143], v3 offset:20480
    v_mfma_f32_16x16x32_bf16 v[88:91], v[46:49], v[162:165], v[88:91]
    ds_read_b64_tr_b16 v[144:145], v3 offset:22528
    v_mfma_f32_16x16x32_bf16 v[52:55], v[162:165], a[80:83], v[52:55]
    ds_read_b64_tr_b16 v[146:147], v4 offset:20480
    v_mfma_f32_16x16x32_bf16 v[68:71], v[162:165], a[144:147], v[68:71]
    ds_read_b64_tr_b16 v[148:149], v4 offset:22528
    s_waitcnt lgkmcnt(8)
    v_mfma_f32_16x16x32_bf16 v[56:59], v[166:169], a[80:83], v[56:59]
    ds_read_b64_tr_b16 v[150:151], v5 offset:20480
    v_mfma_f32_16x16x32_bf16 v[72:75], v[166:169], a[144:147], v[72:75]
    ds_read_b64_tr_b16 v[152:153], v5 offset:22528
    s_waitcnt lgkmcnt(8)
    v_mfma_f32_16x16x32_bf16 v[60:63], v[36:39], a[80:83], v[60:63]
    ds_read_b64_tr_b16 v[154:155], v6 offset:20480
    v_mfma_f32_16x16x32_bf16 v[76:79], v[36:39], a[144:147], v[76:79]
    ds_read_b64_tr_b16 v[156:157], v6 offset:22528
    s_waitcnt lgkmcnt(8)
    v_mfma_f32_16x16x32_bf16 v[64:67], v[138:141], a[80:83], v[64:67]
    ds_read_b64_tr_b16 v[158:159], v3 offset:24576
    v_mfma_f32_16x16x32_bf16 v[80:83], v[138:141], a[144:147], v[80:83]
    ds_read_b64_tr_b16 v[160:161], v3 offset:26624
    s_waitcnt lgkmcnt(8)
    v_mfma_f32_16x16x32_bf16 v[84:87], v[142:145], v[142:145], v[84:87]
    ds_read_b64_tr_b16 v[162:163], v4 offset:24576
    v_mfma_f32_16x16x32_bf16 v[88:91], v[46:49], v[142:145], v[88:91]
    ds_read_b64_tr_b16 v[164:165], v4 offset:26624
    v_mfma_f32_16x16x32_bf16 v[52:55], v[142:145], a[84:87], v[52:55]
    ds_read_b64_tr_b16 v[166:167], v5 offset:24576
    v_mfma_f32_16x16x32_bf16 v[68:71], v[142:145], a[148:151], v[68:71]
    ds_read_b64_tr_b16 v[168:169], v5 offset:26624
    s_waitcnt lgkmcnt(10)
    v_mfma_f32_16x16x32_bf16 v[56:59], v[146:149], a[84:87], v[56:59]
    ds_read_b64_tr_b16 v[36:37], v6 offset:24576
    v_mfma_f32_16x16x32_bf16 v[72:75], v[146:149], a[148:151], v[72:75]
    ds_read_b64_tr_b16 v[38:39], v6 offset:26624
    s_waitcnt lgkmcnt(10)
    v_mfma_f32_16x16x32_bf16 v[60:63], v[150:153], a[84:87], v[60:63]
    ds_read_b64_tr_b16 v[138:139], v3 offset:28672
    v_mfma_f32_16x16x32_bf16 v[76:79], v[150:153], a[148:151], v[76:79]
    ds_read_b64_tr_b16 v[140:141], v3 offset:30720
    s_waitcnt lgkmcnt(10)
    v_mfma_f32_16x16x32_bf16 v[64:67], v[154:157], a[84:87], v[64:67]
    ds_read_b64_tr_b16 v[142:143], v4 offset:28672
    v_mfma_f32_16x16x32_bf16 v[80:83], v[154:157], a[148:151], v[80:83]
    ds_read_b64_tr_b16 v[144:145], v4 offset:30720
    s_waitcnt lgkmcnt(10)
    v_mfma_f32_16x16x32_bf16 v[84:87], v[158:161], v[158:161], v[84:87]
    ds_read_b64_tr_b16 v[146:147], v5 offset:28672
    v_mfma_f32_16x16x32_bf16 v[88:91], v[46:49], v[158:161], v[88:91]
    ds_read_b64_tr_b16 v[148:149], v5 offset:30720
    v_mfma_f32_16x16x32_bf16 v[52:55], v[158:161], a[88:91], v[52:55]
    ds_read_b64_tr_b16 v[150:151], v6 offset:28672
    v_mfma_f32_16x16x32_bf16 v[68:71], v[158:161], a[152:155], v[68:71]
    ds_read_b64_tr_b16 v[152:153], v6 offset:30720
    s_waitcnt lgkmcnt(12)
    v_mfma_f32_16x16x32_bf16 v[56:59], v[162:165], a[88:91], v[56:59]
    s_waitcnt vmcnt(4)
    s_barrier
    ds_read_b64_tr_b16 v[154:155], v3 offset:32768
    v_mfma_f32_16x16x32_bf16 v[72:75], v[162:165], a[152:155], v[72:75]
    ds_read_b64_tr_b16 v[156:157], v3 offset:34816
    s_waitcnt lgkmcnt(12)
    v_mfma_f32_16x16x32_bf16 v[60:63], v[166:169], a[88:91], v[60:63]
    v_mfma_f32_16x16x32_bf16 v[76:79], v[166:169], a[152:155], v[76:79]
    s_waitcnt lgkmcnt(10)
    v_mfma_f32_16x16x32_bf16 v[64:67], v[36:39], a[88:91], v[64:67]
    ds_read_b64_tr_b16 v[158:159], v4 offset:32768
    v_mfma_f32_16x16x32_bf16 v[80:83], v[36:39], a[152:155], v[80:83]
    ds_read_b64_tr_b16 v[160:161], v4 offset:34816
    s_waitcnt lgkmcnt(10)
    v_mfma_f32_16x16x32_bf16 v[84:87], v[138:141], v[138:141], v[84:87]
    ds_read_b64_tr_b16 v[162:163], v5 offset:32768
    v_mfma_f32_16x16x32_bf16 v[88:91], v[46:49], v[138:141], v[88:91]
    ds_read_b64_tr_b16 v[164:165], v5 offset:34816
    v_mfma_f32_16x16x32_bf16 v[52:55], v[138:141], a[92:95], v[52:55]
    ds_read_b64_tr_b16 v[166:167], v6 offset:32768
    v_mfma_f32_16x16x32_bf16 v[68:71], v[138:141], a[156:159], v[68:71]
    ds_read_b64_tr_b16 v[168:169], v6 offset:34816
    s_waitcnt lgkmcnt(12)
    v_mfma_f32_16x16x32_bf16 v[56:59], v[142:145], a[92:95], v[56:59]
    ds_read_b64_tr_b16 v[36:37], v3 offset:36864
    v_mfma_f32_16x16x32_bf16 v[72:75], v[142:145], a[156:159], v[72:75]
    ds_read_b64_tr_b16 v[38:39], v3 offset:38912
    s_waitcnt lgkmcnt(12)
    v_mfma_f32_16x16x32_bf16 v[60:63], v[146:149], a[92:95], v[60:63]
    v_mfma_f32_16x16x32_bf16 v[76:79], v[146:149], a[156:159], v[76:79]
    s_waitcnt lgkmcnt(10)
    v_mfma_f32_16x16x32_bf16 v[64:67], v[150:153], a[92:95], v[64:67]
    ds_read_b64_tr_b16 v[138:139], v4 offset:36864
    v_mfma_f32_16x16x32_bf16 v[80:83], v[150:153], a[156:159], v[80:83]
    ds_read_b64_tr_b16 v[140:141], v4 offset:38912
    s_waitcnt lgkmcnt(10)
    v_mfma_f32_16x16x32_bf16 v[84:87], v[154:157], v[154:157], v[84:87]
    ds_read_b64_tr_b16 v[142:143], v5 offset:36864
    v_mfma_f32_16x16x32_bf16 v[88:91], v[46:49], v[154:157], v[88:91]
    ds_read_b64_tr_b16 v[144:145], v5 offset:38912
    v_mfma_f32_16x16x32_bf16 v[52:55], v[154:157], a[96:99], v[52:55]
    ds_read_b64_tr_b16 v[146:147], v6 offset:36864
    v_mfma_f32_16x16x32_bf16 v[68:71], v[154:157], a[160:163], v[68:71]
    ds_read_b64_tr_b16 v[148:149], v6 offset:38912
    s_waitcnt lgkmcnt(12)
    v_mfma_f32_16x16x32_bf16 v[56:59], v[158:161], a[96:99], v[56:59]
    ds_read_b64_tr_b16 v[150:151], v3 offset:40960
    v_mfma_f32_16x16x32_bf16 v[72:75], v[158:161], a[160:163], v[72:75]
    ds_read_b64_tr_b16 v[152:153], v3 offset:43008
    s_waitcnt lgkmcnt(12)
    v_mfma_f32_16x16x32_bf16 v[60:63], v[162:165], a[96:99], v[60:63]
    v_mfma_f32_16x16x32_bf16 v[76:79], v[162:165], a[160:163], v[76:79]
    s_waitcnt lgkmcnt(10)
    v_mfma_f32_16x16x32_bf16 v[64:67], v[166:169], a[96:99], v[64:67]
    ds_read_b64_tr_b16 v[154:155], v4 offset:40960
    v_mfma_f32_16x16x32_bf16 v[80:83], v[166:169], a[160:163], v[80:83]
    ds_read_b64_tr_b16 v[156:157], v4 offset:43008
    s_waitcnt lgkmcnt(10)
    v_mfma_f32_16x16x32_bf16 v[84:87], v[36:39], v[36:39], v[84:87]
    ds_read_b64_tr_b16 v[158:159], v5 offset:40960
    v_mfma_f32_16x16x32_bf16 v[88:91], v[46:49], v[36:39], v[88:91]
    ds_read_b64_tr_b16 v[160:161], v5 offset:43008
    v_mfma_f32_16x16x32_bf16 v[52:55], v[36:39], a[100:103], v[52:55]
    ds_read_b64_tr_b16 v[162:163], v6 offset:40960
    v_mfma_f32_16x16x32_bf16 v[68:71], v[36:39], a[164:167], v[68:71]
    ds_read_b64_tr_b16 v[164:165], v6 offset:43008
    s_waitcnt lgkmcnt(12)
    v_mfma_f32_16x16x32_bf16 v[56:59], v[138:141], a[100:103], v[56:59]
    ds_read_b64_tr_b16 v[166:167], v3 offset:45056
    v_mfma_f32_16x16x32_bf16 v[72:75], v[138:141], a[164:167], v[72:75]
    ds_read_b64_tr_b16 v[168:169], v3 offset:47104
    s_waitcnt lgkmcnt(12)
    v_mfma_f32_16x16x32_bf16 v[60:63], v[142:145], a[100:103], v[60:63]
    v_mfma_f32_16x16x32_bf16 v[76:79], v[142:145], a[164:167], v[76:79]
    s_waitcnt lgkmcnt(10)
    v_mfma_f32_16x16x32_bf16 v[64:67], v[146:149], a[100:103], v[64:67]
    ds_read_b64_tr_b16 v[36:37], v4 offset:45056
    v_mfma_f32_16x16x32_bf16 v[80:83], v[146:149], a[164:167], v[80:83]
    ds_read_b64_tr_b16 v[38:39], v4 offset:47104
    s_waitcnt lgkmcnt(10)
    v_mfma_f32_16x16x32_bf16 v[84:87], v[150:153], v[150:153], v[84:87]
    ds_read_b64_tr_b16 v[138:139], v5 offset:45056
    v_mfma_f32_16x16x32_bf16 v[88:91], v[46:49], v[150:153], v[88:91]
    ds_read_b64_tr_b16 v[140:141], v5 offset:47104
    v_mfma_f32_16x16x32_bf16 v[52:55], v[150:153], a[104:107], v[52:55]
    ds_read_b64_tr_b16 v[142:143], v6 offset:45056
    v_mfma_f32_16x16x32_bf16 v[68:71], v[150:153], a[168:171], v[68:71]
    ds_read_b64_tr_b16 v[144:145], v6 offset:47104
    s_waitcnt lgkmcnt(12)
    v_mfma_f32_16x16x32_bf16 v[56:59], v[154:157], a[104:107], v[56:59]
    s_waitcnt vmcnt(0)
    s_barrier
    s_cmp_lg_u32 s67, 1
    s_cbranch_scc1 L_nofbx1
    s_mov_b32 s53, 0x2c000
    v_mov_b32 v34, 1
    s_mov_b64 exec, 1
    buffer_atomic_add v34, v32, s[36:39], s53 offen
    s_mov_b64 exec, -1
L_nofbx1:
    ds_read_b64_tr_b16 v[146:147], v3 offset:49152
    v_mfma_f32_16x16x32_bf16 v[72:75], v[154:157], a[168:171], v[72:75]
    ds_read_b64_tr_b16 v[148:149], v3 offset:51200
    s_waitcnt lgkmcnt(12)
    v_mfma_f32_16x16x32_bf16 v[60:63], v[158:161], a[104:107], v[60:63]
    v_mfma_f32_16x16x32_bf16 v[76:79], v[158:161], a[168:171], v[76:79]
    s_waitcnt lgkmcnt(10)
    v_mfma_f32_16x16x32_bf16 v[64:67], v[162:165], a[104:107], v[64:67]
    ds_read_b64_tr_b16 v[150:151], v3 offset:53248
    v_mfma_f32_16x16x32_bf16 v[80:83], v[162:165], a[168:171], v[80:83]
    ds_read_b64_tr_b16 v[152:153], v3 offset:55296
    s_waitcnt lgkmcnt(10)
    v_mfma_f32_16x16x32_bf16 v[84:87], v[166:169], v[166:169], v[84:87]
    v_mfma_f32_16x16x32_bf16 v[88:91], v[46:49], v[166:169], v[88:91]
    v_mfma_f32_16x16x32_bf16 v[52:55], v[166:169], a[108:111], v[52:55]
    ds_read_b64_tr_b16 v[154:155], v3 offset:57344
    v_mfma_f32_16x16x32_bf16 v[68:71], v[166:169], a[172:175], v[68:71]
    ds_read_b64_tr_b16 v[156:157], v3 offset:59392
    s_waitcnt lgkmcnt(10)
    v_mfma_f32_16x16x32_bf16 v[56:59], v[36:39], a[108:111], v[56:59]
    v_mfma_f32_16x16x32_bf16 v[72:75], v[36:39], a[172:175], v[72:75]
    s_waitcnt lgkmcnt(8)
    v_mfma_f32_16x16x32_bf16 v[60:63], v[138:141], a[108:111], v[60:63]
    ds_read_b64_tr_b16 v[158:159], v3 offset:61440
    v_mfma_f32_16x16x32_bf16 v[76:79], v[138:141], a[172:175], v[76:79]
    ds_read_b64_tr_b16 v[160:161], v3 offset:63488
    s_waitcnt lgkmcnt(8)
    v_mfma_f32_16x16x32_bf16 v[64:67], v[142:145], a[108:111], v[64:67]
    v_mfma_f32_16x16x32_bf16 v[80:83], v[142:145], a[172:175], v[80:83]
    s_waitcnt lgkmcnt(6)
    v_mfma_f32_16x16x32_bf16 v[84:87], v[146:149], v[146:149], v[84:87]
    ds_read_b64_tr_b16 v[162:163], v4 offset:49152
    v_mfma_f32_16x16x32_bf16 v[88:91], v[46:49], v[146:149], v[88:91]
    ds_read_b64_tr_b16 v[164:165], v4 offset:51200
    v_mfma_f32_16x16x32_bf16 v[52:55], v[146:149], a[112:115], v[52:55]
    ds_read_b64_tr_b16 v[166:167], v4 offset:53248
    v_mfma_f32_16x16x32_bf16 v[68:71], v[146:149], a[176:179], v[68:71]
    ds_read_b64_tr_b16 v[168:169], v4 offset:55296
    s_waitcnt lgkmcnt(8)
    v_mfma_f32_16x16x32_bf16 v[84:87], v[150:153], v[150:153], v[84:87]
    ds_read_b64_tr_b16 v[36:37], v4 offset:57344
    v_mfma_f32_16x16x32_bf16 v[88:91], v[46:49], v[150:153], v[88:91]
    ds_read_b64_tr_b16 v[38:39], v4 offset:59392
    v_mfma_f32_16x16x32_bf16 v[52:55], v[150:153], a[116:119], v[52:55]
    ds_read_b64_tr_b16 v[138:139], v4 offset:61440
    v_mfma_f32_16x16x32_bf16 v[68:71], v[150:153], a[180:183], v[68:71]
    ds_read_b64_tr_b16 v[140:141], v4 offset:63488
    s_waitcnt lgkmcnt(10)
    v_mfma_f32_16x16x32_bf16 v[84:87], v[154:157], v[154:157], v[84:87]
    ds_read_b64_tr_b16 v[142:143], v5 offset:49152
    v_mfma_f32_16x16x32_bf16 v[88:91], v[46:49], v[154:157], v[88:91]
    ds_read_b64_tr_b16 v[144:145], v5 offset:51200
    v_xor_b32 v132, 64, v31
    v_mfma_f32_16x16x32_bf16 v[52:55], v[154:157], a[120:123], v[52:55]
    ds_read_b64_tr_b16 v[146:147], v5 offset:53248
    v_xor_b32_e64 v133, 64, v30
    v_mfma_f32_16x16x32_bf16 v[68:71], v[154:157], a[184:187], v[68:71]
    ds_read_b64_tr_b16 v[148:149], v5 offset:55296
    v_xor_b32 v134, 128, v31
    s_waitcnt lgkmcnt(12)
    v_mfma_f32_16x16x32_bf16 v[84:87], v[158:161], v[158:161], v[84:87]
    ds_read_b64_tr_b16 v[150:151], v5 offset:57344
    s_nop 0
    v_xor_b32 v135, 128, v30
    v_mfma_f32_16x16x32_bf16 v[88:91], v[46:49], v[158:161], v[88:91]
    ds_read_b64_tr_b16 v[152:153], v5 offset:59392
    v_xor_b32 v136, 192, v31
    v_mfma_f32_16x16x32_bf16 v[52:55], v[158:161], a[124:127], v[52:55]
    ds_read_b64_tr_b16 v[154:155], v5 offset:61440
    v_xor_b32 v137, 192, v30
    v_mfma_f32_16x16x32_bf16 v[68:71], v[158:161], a[188:191], v[68:71]
    ds_read_b64_tr_b16 v[156:157], v5 offset:63488
    s_waitcnt lgkmcnt(14)
    v_mfma_f32_16x16x32_bf16 v[56:59], v[162:165], a[112:115], v[56:59]
    ds_read_b64_tr_b16 v[158:159], v6 offset:49152
    v_mfma_f32_16x16x32_bf16 v[72:75], v[162:165], a[176:179], v[72:75]
    ds_read_b64_tr_b16 v[160:161], v6 offset:51200
    v_cndmask_b32 v84, v84, v85, s[22:23]
    v_cndmask_b32 v86, v86, v87, s[22:23]
    s_waitcnt lgkmcnt(14)
    v_mfma_f32_16x16x32_bf16 v[56:59], v[166:169], a[116:119], v[56:59]
    ds_read_b64_tr_b16 v[162:163], v6 offset:53248
    v_mul_f32_e64 v88, s62, v88
    v_mfma_f32_16x16x32_bf16 v[72:75], v[166:169], a[180:183], v[72:75]
    ds_read_b64_tr_b16 v[164:165], v6 offset:55296
    v_cndmask_b32 v84, v84, v86, s[34:35]
    v_mul_f32 v85, v88, v88
    s_waitcnt lgkmcnt(14)
    v_mfma_f32_16x16x32_bf16 v[56:59], v[36:39], a[120:123], v[56:59]
    ds_read_b64_tr_b16 v[166:167], v6 offset:57344
    v_fma_f32 v85, v84, s62, -v85
    v_cvt_pk_bf16_f32 v88, v88, v88
    v_mfma_f32_16x16x32_bf16 v[72:75], v[36:39], a[184:187], v[72:75]
    ds_read_b64_tr_b16 v[168:169], v6 offset:59392
    v_max_f32 v85, 0, v85
    v_add_f32 v85, s63, v85
    s_waitcnt lgkmcnt(14)
    v_mfma_f32_16x16x32_bf16 v[56:59], v[138:141], a[124:127], v[56:59]
    ds_read_b64_tr_b16 v[36:37], v6 offset:61440
    v_rsq_f32 v85, v85
    v_and_b32 v88, 0xffff0000, v88
    v_mfma_f32_16x16x32_bf16 v[72:75], v[138:141], a[188:191], v[72:75]
    ds_read_b64_tr_b16 v[38:39], v6 offset:63488
    v_mul_f32 v84, v88, v85
    s_waitcnt lgkmcnt(14)
    v_mfma_f32_16x16x32_bf16 v[60:63], v[142:145], a[112:115], v[60:63]
    s_mov_b32 exec_lo, 0x00f0000f
    s_mov_b32 exec_hi, 0xf0000f00
    ds_write2st64_b32 v30, v85, v84 offset0:0 offset1:1
    s_mov_b64 exec, -1
    v_mfma_f32_16x16x32_bf16 v[76:79], v[142:145], a[176:179], v[76:79]
    s_waitcnt lgkmcnt(13)
    v_mfma_f32_16x16x32_bf16 v[60:63], v[146:149], a[116:119], v[60:63]
    v_mfma_f32_16x16x32_bf16 v[76:79], v[146:149], a[180:183], v[76:79]
    s_waitcnt lgkmcnt(0)
    s_barrier
    v_mfma_f32_16x16x32_bf16 v[60:63], v[150:153], a[120:123], v[60:63]
    ds_read_b128 v[96:99], v31 offset:256
    v_mfma_f32_16x16x32_bf16 v[76:79], v[150:153], a[184:187], v[76:79]
    ds_read_b128 v[92:95], v31
    v_mfma_f32_16x16x32_bf16 v[60:63], v[154:157], a[124:127], v[60:63]
    ds_read_b128 v[104:107], v132 offset:256
    v_mfma_f32_16x16x32_bf16 v[76:79], v[154:157], a[188:191], v[76:79]
    ds_read_b128 v[100:103], v132
    v_mfma_f32_16x16x32_bf16 v[64:67], v[158:161], a[112:115], v[64:67]
    ds_read_b128 v[112:115], v134 offset:256
    v_mfma_f32_16x16x32_bf16 v[80:83], v[158:161], a[176:179], v[80:83]
    ds_read_b128 v[108:111], v134
    v_mfma_f32_16x16x32_bf16 v[64:67], v[162:165], a[116:119], v[64:67]
    ds_read_b128 v[120:123], v136 offset:256
    v_mfma_f32_16x16x32_bf16 v[80:83], v[162:165], a[180:183], v[80:83]
    ds_read_b128 v[116:119], v136
    v_mfma_f32_16x16x32_bf16 v[64:67], v[166:169], a[120:123], v[64:67]
    ds_read2st64_b32 v[124:125], v30 offset0:0 offset1:1
    v_mfma_f32_16x16x32_bf16 v[80:83], v[166:169], a[184:187], v[80:83]
    ds_read2st64_b32 v[126:127], v133 offset0:0 offset1:1
    v_mfma_f32_16x16x32_bf16 v[64:67], v[36:39], a[124:127], v[64:67]
    ds_read2st64_b32 v[128:129], v135 offset0:0 offset1:1
    v_mfma_f32_16x16x32_bf16 v[80:83], v[36:39], a[188:191], v[80:83]
    ds_read2st64_b32 v[130:131], v137 offset0:0 offset1:1
    s_waitcnt lgkmcnt(11)
    v_pk_fma_f32 v[36:37], v[96:97], v[40:41], s[66:67] op_sel:[0,0,0] op_sel_hi:[1,0,0] neg_lo:[1,0,0] neg_hi:[1,0,0]
    v_pk_fma_f32 v[38:39], v[98:99], v[40:41], s[66:67] op_sel:[0,0,0] op_sel_hi:[1,0,0] neg_lo:[1,0,0] neg_hi:[1,0,0]
    s_waitcnt lgkmcnt(10)
    v_pk_fma_f32 v[52:53], v[52:53], v[92:93], v[36:37] op_sel:[0,0,0] op_sel_hi:[1,1,1]
    v_pk_fma_f32 v[54:55], v[54:55], v[94:95], v[38:39] op_sel:[0,0,0] op_sel_hi:[1,1,1]
    v_pk_mul_f32 v[68:69], v[68:69], v[92:93] op_sel:[0,0] op_sel_hi:[1,1]
    v_pk_mul_f32 v[70:71], v[70:71], v[94:95] op_sel:[0,0] op_sel_hi:[1,1]
    v_pk_fma_f32 v[68:69], v[96:97], v[40:41], v[68:69] op_sel:[0,1,0] op_sel_hi:[1,1,1] neg_lo:[1,0,0] neg_hi:[1,0,0]
    v_pk_fma_f32 v[70:71], v[98:99], v[40:41], v[70:71] op_sel:[0,1,0] op_sel_hi:[1,1,1] neg_lo:[1,0,0] neg_hi:[1,0,0]
    v_pk_fma_f32 v[36:37], v[52:53], s[64:65], s[64:65] op_sel:[0,0,1] op_sel_hi:[1,0,1]
    v_pk_fma_f32 v[38:39], v[54:55], s[64:65], s[64:65] op_sel:[0,0,1] op_sel_hi:[1,0,1]
    v_exp_f32_e64 v36, v36 clamp
    v_exp_f32_e64 v37, v37 clamp
    v_exp_f32_e64 v38, v38 clamp
    v_exp_f32_e64 v39, v39 clamp
    v_max_f32 v52, s66, v52
    v_max_f32 v53, s66, v53
    v_max_f32 v54, s66, v54
    v_max_f32 v55, s66, v55
    v_pk_add_f32 v[52:53], v[52:53], v[36:37] op_sel:[0,0] op_sel_hi:[1,1]
    v_pk_add_f32 v[54:55], v[54:55], v[38:39] op_sel:[0,0] op_sel_hi:[1,1]
    v_cvt_pk_bf16_f32 v132, v68, v69
    v_cvt_pk_bf16_f32 v133, v70, v71
    v_cvt_pk_bf16_f32 v84, v52, v53
    v_cvt_pk_bf16_f32 v85, v54, v55
    s_waitcnt lgkmcnt(9)
    v_pk_fma_f32 v[36:37], v[104:105], v[40:41], s[66:67] op_sel:[0,0,0] op_sel_hi:[1,0,0] neg_lo:[1,0,0] neg_hi:[1,0,0]
    v_pk_fma_f32 v[38:39], v[106:107], v[40:41], s[66:67] op_sel:[0,0,0] op_sel_hi:[1,0,0] neg_lo:[1,0,0] neg_hi:[1,0,0]
    s_waitcnt lgkmcnt(8)
    v_pk_fma_f32 v[56:57], v[56:57], v[100:101], v[36:37] op_sel:[0,0,0] op_sel_hi:[1,1,1]
    v_pk_fma_f32 v[58:59], v[58:59], v[102:103], v[38:39] op_sel:[0,0,0] op_sel_hi:[1,1,1]
    v_pk_mul_f32 v[72:73], v[72:73], v[100:101] op_sel:[0,0] op_sel_hi:[1,1]
    v_pk_mul_f32 v[74:75], v[74:75], v[102:103] op_sel:[0,0] op_sel_hi:[1,1]
    v_pk_fma_f32 v[72:73], v[104:105], v[40:41], v[72:73] op_sel:[0,1,0] op_sel_hi:[1,1,1] neg_lo:[1,0,0] neg_hi:[1,0,0]
    v_pk_fma_f32 v[74:75], v[106:107], v[40:41], v[74:75] op_sel:[0,1,0] op_sel_hi:[1,1,1] neg_lo:[1,0,0] neg_hi:[1,0,0]
    v_pk_fma_f32 v[36:37], v[56:57], s[64:65], s[64:65] op_sel:[0,0,1] op_sel_hi:[1,0,1]
    v_pk_fma_f32 v[38:39], v[58:59], s[64:65], s[64:65] op_sel:[0,0,1] op_sel_hi:[1,0,1]
    v_exp_f32_e64 v36, v36 clamp
    v_exp_f32_e64 v37, v37 clamp
    v_exp_f32_e64 v38, v38 clamp
    v_exp_f32_e64 v39, v39 clamp
    v_max_f32 v56, s66, v56
    v_max_f32 v57, s66, v57
    v_max_f32 v58, s66, v58
    v_max_f32 v59, s66, v59
    v_pk_add_f32 v[56:57], v[56:57], v[36:37] op_sel:[0,0] op_sel_hi:[1,1]
    v_pk_add_f32 v[58:59], v[58:59], v[38:39] op_sel:[0,0] op_sel_hi:[1,1]
    v_cvt_pk_bf16_f32 v134, v72, v73
    v_cvt_pk_bf16_f32 v135, v74, v75
    v_cvt_pk_bf16_f32 v86, v56, v57
    v_cvt_pk_bf16_f32 v87, v58, v59
    s_waitcnt lgkmcnt(7)
    v_pk_fma_f32 v[36:37], v[112:113], v[40:41], s[66:67] op_sel:[0,0,0] op_sel_hi:[1,0,0] neg_lo:[1,0,0] neg_hi:[1,0,0]
    v_pk_fma_f32 v[38:39], v[114:115], v[40:41], s[66:67] op_sel:[0,0,0] op_sel_hi:[1,0,0] neg_lo:[1,0,0] neg_hi:[1,0,0]
    s_waitcnt lgkmcnt(6)
    v_pk_fma_f32 v[60:61], v[60:61], v[108:109], v[36:37] op_sel:[0,0,0] op_sel_hi:[1,1,1]
    v_pk_fma_f32 v[62:63], v[62:63], v[110:111], v[38:39] op_sel:[0,0,0] op_sel_hi:[1,1,1]
    v_pk_mul_f32 v[76:77], v[76:77], v[108:109] op_sel:[0,0] op_sel_hi:[1,1]
    v_pk_mul_f32 v[78:79], v[78:79], v[110:111] op_sel:[0,0] op_sel_hi:[1,1]
    v_pk_fma_f32 v[76:77], v[112:113], v[40:41], v[76:77] op_sel:[0,1,0] op_sel_hi:[1,1,1] neg_lo:[1,0,0] neg_hi:[1,0,0]
    v_pk_fma_f32 v[78:79], v[114:115], v[40:41], v[78:79] op_sel:[0,1,0] op_sel_hi:[1,1,1] neg_lo:[1,0,0] neg_hi:[1,0,0]
    v_pk_fma_f32 v[36:37], v[60:61], s[64:65], s[64:65] op_sel:[0,0,1] op_sel_hi:[1,0,1]
    v_pk_fma_f32 v[38:39], v[62:63], s[64:65], s[64:65] op_sel:[0,0,1] op_sel_hi:[1,0,1]
    v_mfma_f32_16x16x32_bf16 v[140:143], v[132:135], v[84:87], 0
    v_exp_f32_e64 v36, v36 clamp
    v_exp_f32_e64 v37, v37 clamp
    v_mfma_f32_16x16x32_bf16 v[144:147], v[46:49], v[84:87], 0
    v_exp_f32_e64 v38, v38 clamp
    v_exp_f32_e64 v39, v39 clamp
    v_max_f32 v60, s66, v60
    v_max_f32 v61, s66, v61
    v_max_f32 v62, s66, v62
    v_max_f32 v63, s66, v63
    v_pk_add_f32 v[60:61], v[60:61], v[36:37] op_sel:[0,0] op_sel_hi:[1,1]
    v_pk_add_f32 v[62:63], v[62:63], v[38:39] op_sel:[0,0] op_sel_hi:[1,1]
    v_cvt_pk_bf16_f32 v136, v76, v77
    v_cvt_pk_bf16_f32 v137, v78, v79
    v_cvt_pk_bf16_f32 v88, v60, v61
    v_cvt_pk_bf16_f32 v89, v62, v63
    s_waitcnt lgkmcnt(5)
    v_pk_fma_f32 v[36:37], v[120:121], v[40:41], s[66:67] op_sel:[0,0,0] op_sel_hi:[1,0,0] neg_lo:[1,0,0] neg_hi:[1,0,0]
    v_pk_fma_f32 v[38:39], v[122:123], v[40:41], s[66:67] op_sel:[0,0,0] op_sel_hi:[1,0,0] neg_lo:[1,0,0] neg_hi:[1,0,0]
    s_waitcnt lgkmcnt(4)
    v_pk_fma_f32 v[64:65], v[64:65], v[116:117], v[36:37] op_sel:[0,0,0] op_sel_hi:[1,1,1]
    v_pk_fma_f32 v[66:67], v[66:67], v[118:119], v[38:39] op_sel:[0,0,0] op_sel_hi:[1,1,1]
    v_pk_mul_f32 v[80:81], v[80:81], v[116:117] op_sel:[0,0] op_sel_hi:[1,1]
    v_pk_mul_f32 v[82:83], v[82:83], v[118:119] op_sel:[0,0] op_sel_hi:[1,1]
    v_pk_fma_f32 v[80:81], v[120:121], v[40:41], v[80:81] op_sel:[0,1,0] op_sel_hi:[1,1,1] neg_lo:[1,0,0] neg_hi:[1,0,0]
    v_pk_fma_f32 v[82:83], v[122:123], v[40:41], v[82:83] op_sel:[0,1,0] op_sel_hi:[1,1,1] neg_lo:[1,0,0] neg_hi:[1,0,0]
    v_pk_fma_f32 v[36:37], v[64:65], s[64:65], s[64:65] op_sel:[0,0,1] op_sel_hi:[1,0,1]
    v_pk_fma_f32 v[38:39], v[66:67], s[64:65], s[64:65] op_sel:[0,0,1] op_sel_hi:[1,0,1]
    v_exp_f32_e64 v36, v36 clamp
    v_exp_f32_e64 v37, v37 clamp
    v_exp_f32_e64 v38, v38 clamp
    v_exp_f32_e64 v39, v39 clamp
    v_max_f32 v64, s66, v64
    v_max_f32 v65, s66, v65
    v_max_f32 v66, s66, v66
    v_max_f32 v67, s66, v67
    v_pk_add_f32 v[64:65], v[64:65], v[36:37] op_sel:[0,0] op_sel_hi:[1,1]
    v_pk_add_f32 v[66:67], v[66:67], v[38:39] op_sel:[0,0] op_sel_hi:[1,1]
    v_cvt_pk_bf16_f32 v138, v80, v81
    v_cvt_pk_bf16_f32 v139, v82, v83
    v_cvt_pk_bf16_f32 v90, v64, v65
    v_cvt_pk_bf16_f32 v91, v66, v67
    s_waitcnt lgkmcnt(2)
    v_cmp_u_f32 vcc, v125, v127
    s_waitcnt lgkmcnt(0)
    v_cmp_u_f32 s[68:69], v129, v131
    s_nop 0
    s_or_b64 vcc, vcc, s[68:69]
    s_cbranch_scc1 L_slowx1
L_okx1:
    s_mov_b32 s55, 0x1c000
    s_mov_b32 s53, 0x24000
    v_mfma_f32_16x16x32_bf16 v[140:143], v[136:139], v[88:91], v[140:143]
    v_mfma_f32_16x16x32_bf16 v[144:147], v[46:49], v[88:91], v[144:147]
    ds_read_b64_tr_b16 v[68:69], v3 offset:0
    ds_read_b64_tr_b16 v[70:71], v3 offset:2048
    ds_read_b64_tr_b16 v[72:73], v4 offset:0
L_stub_s5_0:
    s_cbranch_execz L_tback_s5
    s_nop 0
    ds_read_b64_tr_b16 v[74:75], v4 offset:2048
    s_nop 2
    s_nop 0
    buffer_atomic_add_f32 v140, v22, s[36:39], s55 offen offset:0
    buffer_atomic_add_f32 v141, v22, s[36:39], s55 offen offset:128
    buffer_atomic_add_f32 v142, v22, s[36:39], s55 offen offset:256
    buffer_atomic_add_f32 v143, v22, s[36:39], s55 offen offset:384
    s_mov_b64 exec, 0xffff
    buffer_atomic_add_f32 v144, v23, s[36:39], s53 offen
    s_mov_b64 exec, -1
    ds_read_b64_tr_b16 v[76:77], v5 offset:0
    ds_read_b64_tr_b16 v[78:79], v5 offset:2048
    ds_read_b64_tr_b16 v[80:81], v6 offset:0
    ds_read_b64_tr_b16 v[82:83], v6 offset:2048
    ds_read_b64_tr_b16 v[84:85], v3 offset:4096
    ds_read_b64_tr_b16 v[86:87], v3 offset:6144
    s_waitcnt lgkmcnt(8)
    v_mfma_f32_16x16x32_bf16 v[52:55], a[0:3], v[68:71], 0
    ds_read_b64_tr_b16 v[88:89], v4 offset:4096
    s_waitcnt lgkmcnt(7)
    ds_read_b64_tr_b16 v[90:91], v4 offset:6144
    v_mfma_f32_16x16x32_bf16 v[56:59], a[0:3], v[72:75], 0
    ds_read_b64_tr_b16 v[92:93], v5 offset:4096
    s_waitcnt lgkmcnt(7)
    ds_read_b64_tr_b16 v[94:95], v5 offset:6144
    v_mfma_f32_16x16x32_bf16 v[60:63], a[0:3], v[76:79], 0
    ds_read_b64_tr_b16 v[96:97], v6 offset:4096
    s_waitcnt lgkmcnt(7)
    ds_read_b64_tr_b16 v[98:99], v6 offset:6144
    v_mfma_f32_16x16x32_bf16 v[64:67], a[0:3], v[80:83], 0
    ds_read_b64_tr_b16 v[68:69], v3 offset:8192
    s_waitcnt lgkmcnt(7)
    ds_read_b64_tr_b16 v[70:71], v3 offset:10240
    v_mfma_f32_16x16x32_bf16 v[52:55], a[4:7], v[84:87], v[52:55]
    ds_read_b64_tr_b16 v[72:73], v4 offset:8192
    s_waitcnt lgkmcnt(7)
    ds_read_b64_tr_b16 v[74:75], v4 offset:10240
    v_mfma_f32_16x16x32_bf16 v[56:59], a[4:7], v[88:91], v[56:59]
    ds_read_b64_tr_b16 v[76:77], v5 offset:8192
    s_waitcnt lgkmcnt(7)
    ds_read_b64_tr_b16 v[78:79], v5 offset:10240
    v_mfma_f32_16x16x32_bf16 v[60:63], a[4:7], v[92:95], v[60:63]
    ds_read_b64_tr_b16 v[80:81], v6 offset:8192
    s_waitcnt lgkmcnt(7)
    ds_read_b64_tr_b16 v[82:83], v6 offset:10240
    v_mfma_f32_16x16x32_bf16 v[64:67], a[4:7], v[96:99], v[64:67]
    ds_read_b64_tr_b16 v[84:85], v3 offset:12288
    s_waitcnt lgkmcnt(7)
    ds_read_b64_tr_b16 v[86:87], v3 offset:14336
    v_mfma_f32_16x16x32_bf16 v[52:55], a[8:11], v[68:71], v[52:55]
    ds_read_b64_tr_b16 v[88:89], v4 offset:12288
    s_waitcnt lgkmcnt(7)
    ds_read_b64_tr_b16 v[90:91], v4 offset:14336
    v_mfma_f32_16x16x32_bf16 v[56:59], a[8:11], v[72:75], v[56:59]
    ds_read_b64_tr_b16 v[92:93], v5 offset:12288
    s_waitcnt lgkmcnt(7)
    ds_read_b64_tr_b16 v[94:95], v5 offset:14336
    v_mfma_f32_16x16x32_bf16 v[60:63], a[8:11], v[76:79], v[60:63]
    ds_read_b64_tr_b16 v[96:97], v6 offset:12288
    s_waitcnt lgkmcnt(7)
    ds_read_b64_tr_b16 v[98:99], v6 offset:14336
    v_mfma_f32_16x16x32_bf16 v[64:67], a[8:11], v[80:83], v[64:67]
    ds_read_b64_tr_b16 v[68:69], v3 offset:16384
    s_waitcnt lgkmcnt(7)
    ds_read_b64_tr_b16 v[70:71], v3 offset:18432
    v_mfma_f32_16x16x32_bf16 v[52:55], a[12:15], v[84:87], v[52:55]
    ds_read_b64_tr_b16 v[72:73], v4 offset:16384
    s_waitcnt lgkmcnt(7)
    ds_read_b64_tr_b16 v[74:75], v4 offset:18432
    v_mfma_f32_16x16x32_bf16 v[56:59], a[12:15], v[88:91], v[56:59]
    ds_read_b64_tr_b16 v[76:77], v5 offset:16384
    s_waitcnt lgkmcnt(7)
    ds_read_b64_tr_b16 v[78:79], v5 offset:18432
    v_mfma_f32_16x16x32_bf16 v[60:63], a[12:15], v[92:95], v[60:63]
    ds_read_b64_tr_b16 v[80:81], v6 offset:16384
    s_waitcnt lgkmcnt(7)
    ds_read_b64_tr_b16 v[82:83], v6 offset:18432
    v_mfma_f32_16x16x32_bf16 v[64:67], a[12:15], v[96:99], v[64:67]
    ds_read_b64_tr_b16 v[84:85], v3 offset:20480
    s_waitcnt lgkmcnt(7)
    ds_read_b64_tr_b16 v[86:87], v3 offset:22528
    v_mfma_f32_16x16x32_bf16 v[52:55], a[16:19], v[68:71], v[52:55]
    ds_read_b64_tr_b16 v[88:89], v4 offset:20480
    s_waitcnt lgkmcnt(7)
    ds_read_b64_tr_b16 v[90:91], v4 offset:22528
    v_mfma_f32_16x16x32_bf16 v[56:59], a[16:19], v[72:75], v[56:59]
    ds_read_b64_tr_b16 v[92:93], v5 offset:20480
    s_waitcnt lgkmcnt(7)
    ds_read_b64_tr_b16 v[94:95], v5 offset:22528
    v_mfma_f32_16x16x32_bf16 v[60:63], a[16:19], v[76:79], v[60:63]
    ds_read_b64_tr_b16 v[96:97], v6 offset:20480
    s_waitcnt lgkmcnt(7)
    ds_read_b64_tr_b16 v[98:99], v6 offset:22528
    v_mfma_f32_16x16x32_bf16 v[64:67], a[16:19], v[80:83], v[64:67]
    ds_read_b64_tr_b16 v[68:69], v3 offset:24576
    s_waitcnt lgkmcnt(7)
    ds_read_b64_tr_b16 v[70:71], v3 offset:26624
    v_mfma_f32_16x16x32_bf16 v[52:55], a[20:23], v[84:87], v[52:55]
    ds_read_b64_tr_b16 v[72:73], v4 offset:24576
    s_waitcnt lgkmcnt(7)
    ds_read_b64_tr_b16 v[74:75], v4 offset:26624
    v_mfma_f32_16x16x32_bf16 v[56:59], a[20:23], v[88:91], v[56:59]
    ds_read_b64_tr_b16 v[76:77], v5 offset:24576
    s_waitcnt lgkmcnt(7)
    ds_read_b64_tr_b16 v[78:79], v5 offset:26624
    v_mfma_f32_16x16x32_bf16 v[60:63], a[20:23], v[92:95], v[60:63]
    ds_read_b64_tr_b16 v[80:81], v6 offset:24576
    s_waitcnt lgkmcnt(7)
    ds_read_b64_tr_b16 v[82:83], v6 offset:26624
    v_mfma_f32_16x16x32_bf16 v[64:67], a[20:23], v[96:99], v[64:67]
    ds_read_b64_tr_b16 v[84:85], v3 offset:28672
    s_waitcnt lgkmcnt(7)
    ds_read_b64_tr_b16 v[86:87], v3 offset:30720
    v_mfma_f32_16x16x32_bf16 v[52:55], a[24:27], v[68:71], v[52:55]
    ds_read_b64_tr_b16 v[88:89], v4 offset:28672
    s_waitcnt lgkmcnt(7)
    ds_read_b64_tr_b16 v[90:91], v4 offset:30720
    v_mfma_f32_16x16x32_bf16 v[56:59], a[24:27], v[72:75], v[56:59]
    ds_read_b64_tr_b16 v[92:93], v5 offset:28672
    s_waitcnt lgkmcnt(7)
    ds_read_b64_tr_b16 v[94:95], v5 offset:30720
    v_mfma_f32_16x16x32_bf16 v[60:63], a[24:27], v[76:79], v[60:63]
    ds_read_b64_tr_b16 v[96:97], v6 offset:28672
    s_waitcnt lgkmcnt(7)
    ds_read_b64_tr_b16 v[98:99], v6 offset:30720
    v_mfma_f32_16x16x32_bf16 v[64:67], a[24:27], v[80:83], v[64:67]
    ds_read_b64_tr_b16 v[68:69], v3 offset:32768
    s_waitcnt lgkmcnt(7)
    ds_read_b64_tr_b16 v[70:71], v3 offset:34816
    v_mfma_f32_16x16x32_bf16 v[52:55], a[28:31], v[84:87], v[52:55]
    ds_read_b64_tr_b16 v[72:73], v4 offset:32768
    s_waitcnt lgkmcnt(7)
    ds_read_b64_tr_b16 v[74:75], v4 offset:34816
    v_mfma_f32_16x16x32_bf16 v[56:59], a[28:31], v[88:91], v[56:59]
    ds_read_b64_tr_b16 v[76:77], v5 offset:32768
    s_waitcnt lgkmcnt(7)
    ds_read_b64_tr_b16 v[78:79], v5 offset:34816
    v_mfma_f32_16x16x32_bf16 v[60:63], a[28:31], v[92:95], v[60:63]
    ds_read_b64_tr_b16 v[80:81], v6 offset:32768
    s_waitcnt lgkmcnt(7)
    ds_read_b64_tr_b16 v[82:83], v6 offset:34816
    v_mfma_f32_16x16x32_bf16 v[64:67], a[28:31], v[96:99], v[64:67]
    ds_read_b64_tr_b16 v[84:85], v3 offset:36864
    s_waitcnt lgkmcnt(7)
    ds_read_b64_tr_b16 v[86:87], v3 offset:38912
    v_mfma_f32_16x16x32_bf16 v[52:55], a[32:35], v[68:71], v[52:55]
    ds_read_b64_tr_b16 v[88:89], v4 offset:36864
    s_waitcnt lgkmcnt(7)
    ds_read_b64_tr_b16 v[90:91], v4 offset:38912
    v_mfma_f32_16x16x32_bf16 v[56:59], a[32:35], v[72:75], v[56:59]
    ds_read_b64_tr_b16 v[92:93], v5 offset:36864
    s_waitcnt lgkmcnt(7)
    ds_read_b64_tr_b16 v[94:95], v5 offset:38912
    v_mfma_f32_16x16x32_bf16 v[60:63], a[32:35], v[76:79], v[60:63]
    ds_read_b64_tr_b16 v[96:97], v6 offset:36864
    s_waitcnt lgkmcnt(7)
    ds_read_b64_tr_b16 v[98:99], v6 offset:38912
    v_mfma_f32_16x16x32_bf16 v[64:67], a[32:35], v[80:83], v[64:67]
    ds_read_b64_tr_b16 v[68:69], v3 offset:40960
    s_waitcnt lgkmcnt(7)
    ds_read_b64_tr_b16 v[70:71], v3 offset:43008
    v_mfma_f32_16x16x32_bf16 v[52:55], a[36:39], v[84:87], v[52:55]
    ds_read_b64_tr_b16 v[72:73], v4 offset:40960
    s_waitcnt lgkmcnt(7)
    ds_read_b64_tr_b16 v[74:75], v4 offset:43008
    v_mfma_f32_16x16x32_bf16 v[56:59], a[36:39], v[88:91], v[56:59]
    ds_read_b64_tr_b16 v[76:77], v5 offset:40960
    s_waitcnt lgkmcnt(7)
    ds_read_b64_tr_b16 v[78:79], v5 offset:43008
    v_mfma_f32_16x16x32_bf16 v[60:63], a[36:39], v[92:95], v[60:63]
    ds_read_b64_tr_b16 v[80:81], v6 offset:40960
    s_waitcnt lgkmcnt(7)
    ds_read_b64_tr_b16 v[82:83], v6 offset:43008
    v_mfma_f32_16x16x32_bf16 v[64:67], a[36:39], v[96:99], v[64:67]
    ds_read_b64_tr_b16 v[84:85], v3 offset:45056
    s_waitcnt lgkmcnt(7)
    ds_read_b64_tr_b16 v[86:87], v3 offset:47104
    v_mfma_f32_16x16x32_bf16 v[52:55], a[40:43], v[68:71], v[52:55]
    ds_read_b64_tr_b16 v[88:89], v4 offset:45056
    s_waitcnt lgkmcnt(7)
    ds_read_b64_tr_b16 v[90:91], v4 offset:47104
    v_mfma_f32_16x16x32_bf16 v[56:59], a[40:43], v[72:75], v[56:59]
    ds_read_b64_tr_b16 v[92:93], v5 offset:45056
    s_waitcnt lgkmcnt(7)
    ds_read_b64_tr_b16 v[94:95], v5 offset:47104
    v_mfma_f32_16x16x32_bf16 v[60:63], a[40:43], v[76:79], v[60:63]
    ds_read_b64_tr_b16 v[96:97], v6 offset:45056
    s_waitcnt lgkmcnt(7)
    ds_read_b64_tr_b16 v[98:99], v6 offset:47104
    v_mfma_f32_16x16x32_bf16 v[64:67], a[40:43], v[80:83], v[64:67]
    ds_read_b64_tr_b16 v[68:69], v3 offset:49152
    s_waitcnt lgkmcnt(7)
    ds_read_b64_tr_b16 v[70:71], v3 offset:51200
    v_mfma_f32_16x16x32_bf16 v[52:55], a[44:47], v[84:87], v[52:55]
    ds_read_b64_tr_b16 v[72:73], v4 offset:49152
    s_waitcnt lgkmcnt(7)
    ds_read_b64_tr_b16 v[74:75], v4 offset:51200
    v_mfma_f32_16x16x32_bf16 v[56:59], a[44:47], v[88:91], v[56:59]
    ds_read_b64_tr_b16 v[76:77], v5 offset:49152
    s_waitcnt lgkmcnt(7)
    ds_read_b64_tr_b16 v[78:79], v5 offset:51200
    v_mfma_f32_16x16x32_bf16 v[60:63], a[44:47], v[92:95], v[60:63]
    ds_read_b64_tr_b16 v[80:81], v6 offset:49152
    s_waitcnt lgkmcnt(7)
    ds_read_b64_tr_b16 v[82:83], v6 offset:51200
    v_mfma_f32_16x16x32_bf16 v[64:67], a[44:47], v[96:99], v[64:67]
    ds_read_b64_tr_b16 v[84:85], v3 offset:53248
    s_waitcnt lgkmcnt(7)
    ds_read_b64_tr_b16 v[86:87], v3 offset:55296
    v_mfma_f32_16x16x32_bf16 v[52:55], a[48:51], v[68:71], v[52:55]
    ds_read_b64_tr_b16 v[88:89], v4 offset:53248
    s_waitcnt lgkmcnt(7)
    ds_read_b64_tr_b16 v[90:91], v4 offset:55296
    v_mfma_f32_16x16x32_bf16 v[56:59], a[48:51], v[72:75], v[56:59]
    ds_read_b64_tr_b16 v[92:93], v5 offset:53248
    s_waitcnt lgkmcnt(7)
    ds_read_b64_tr_b16 v[94:95], v5 offset:55296
    v_mfma_f32_16x16x32_bf16 v[60:63], a[48:51], v[76:79], v[60:63]
    ds_read_b64_tr_b16 v[96:97], v6 offset:53248
    s_waitcnt lgkmcnt(7)
    ds_read_b64_tr_b16 v[98:99], v6 offset:55296
    v_mfma_f32_16x16x32_bf16 v[64:67], a[48:51], v[80:83], v[64:67]
    ds_read_b64_tr_b16 v[68:69], v3 offset:57344
    s_waitcnt lgkmcnt(7)
    ds_read_b64_tr_b16 v[70:71], v3 offset:59392
    v_mfma_f32_16x16x32_bf16 v[52:55], a[52:55], v[84:87], v[52:55]
    ds_read_b64_tr_b16 v[72:73], v4 offset:57344
    s_waitcnt lgkmcnt(7)
    ds_read_b64_tr_b16 v[74:75], v4 offset:59392
    v_mfma_f32_16x16x32_bf16 v[56:59], a[52:55], v[88:91], v[56:59]
    ds_read_b64_tr_b16 v[76:77], v5 offset:57344
    s_waitcnt lgkmcnt(7)
    ds_read_b64_tr_b16 v[78:79], v5 offset:59392
    v_mfma_f32_16x16x32_bf16 v[60:63], a[52:55], v[92:95], v[60:63]
    ds_read_b64_tr_b16 v[80:81], v6 offset:57344
    s_waitcnt lgkmcnt(7)
    ds_read_b64_tr_b16 v[82:83], v6 offset:59392
    v_mfma_f32_16x16x32_bf16 v[64:67], a[52:55], v[96:99], v[64:67]
    ds_read_b64_tr_b16 v[84:85], v3 offset:61440
    s_waitcnt lgkmcnt(7)
    ds_read_b64_tr_b16 v[86:87], v3 offset:63488
    v_mfma_f32_16x16x32_bf16 v[52:55], a[56:59], v[68:71], v[52:55]
    ds_read_b64_tr_b16 v[88:89], v4 offset:61440
    s_waitcnt lgkmcnt(7)
    ds_read_b64_tr_b16 v[90:91], v4 offset:63488
    v_mfma_f32_16x16x32_bf16 v[56:59], a[56:59], v[72:75], v[56:59]
    ds_read_b64_tr_b16 v[92:93], v5 offset:61440
    s_waitcnt lgkmcnt(7)
    ds_read_b64_tr_b16 v[94:95], v5 offset:63488
    v_mfma_f32_16x16x32_bf16 v[60:63], a[56:59], v[76:79], v[60:63]
    ds_read_b64_tr_b16 v[96:97], v6 offset:61440
    s_waitcnt lgkmcnt(7)
    ds_read_b64_tr_b16 v[98:99], v6 offset:63488
    v_mfma_f32_16x16x32_bf16 v[64:67], a[56:59], v[80:83], v[64:67]
    s_waitcnt lgkmcnt(6)
    v_mfma_f32_16x16x32_bf16 v[52:55], a[60:63], v[84:87], v[52:55]
    s_waitcnt lgkmcnt(4)
    v_mfma_f32_16x16x32_bf16 v[56:59], a[60:63], v[88:91], v[56:59]
    s_waitcnt lgkmcnt(2)
    v_mfma_f32_16x16x32_bf16 v[60:63], a[60:63], v[92:95], v[60:63]
    s_waitcnt lgkmcnt(0)
    v_mfma_f32_16x16x32_bf16 v[64:67], a[60:63], v[96:99], v[64:67]
    s_nop 0
    s_mov_b32 s53, 0xc00000
    v_xor_b32 v69, 512, v21
    v_xor_b32 v70, 32768, v21
    v_xor_b32 v71, 33280, v21
    v_pk_fma_f32 v[36:37], v[124:125], v[42:43], s[66:67] op_sel:[1,0,0] op_sel_hi:[1,1,0] neg_lo:[1,0,0] neg_hi:[1,0,0]
    v_pk_fma_f32 v[38:39], v[124:125], v[44:45], s[66:67] op_sel:[1,0,0] op_sel_hi:[1,1,0] neg_lo:[1,0,0] neg_hi:[1,0,0]
    v_pk_fma_f32 v[52:53], v[52:53], v[124:125], v[36:37] op_sel:[0,0,0] op_sel_hi:[1,0,1]
    v_pk_fma_f32 v[54:55], v[54:55], v[124:125], v[38:39] op_sel:[0,0,0] op_sel_hi:[1,0,1]
    v_pk_fma_f32 v[36:37], v[52:53], s[64:65], s[64:65] op_sel:[0,0,1] op_sel_hi:[1,0,1]
    v_pk_fma_f32 v[38:39], v[54:55], s[64:65], s[64:65] op_sel:[0,0,1] op_sel_hi:[1,0,1]
    v_exp_f32_e64 v36, v36 clamp
    v_exp_f32_e64 v37, v37 clamp
    v_exp_f32_e64 v38, v38 clamp
    v_exp_f32_e64 v39, v39 clamp
    v_max_f32 v52, s66, v52
    v_max_f32 v53, s66, v53
    v_max_f32 v54, s66, v54
    v_max_f32 v55, s66, v55
    v_pk_add_f32 v[52:53], v[52:53], v[36:37] op_sel:[0,0] op_sel_hi:[1,1]
    v_pk_add_f32 v[54:55], v[54:55], v[38:39] op_sel:[0,0] op_sel_hi:[1,1]
    v_cvt_pk_bf16_f32 v52, v52, v53
    v_cvt_pk_bf16_f32 v53, v54, v55
    buffer_store_dwordx2 v[52:53], v21, s[36:39], s53 offen sc1
    v_pk_fma_f32 v[36:37], v[126:127], v[42:43], s[66:67] op_sel:[1,0,0] op_sel_hi:[1,1,0] neg_lo:[1,0,0] neg_hi:[1,0,0]
    v_pk_fma_f32 v[38:39], v[126:127], v[44:45], s[66:67] op_sel:[1,0,0] op_sel_hi:[1,1,0] neg_lo:[1,0,0] neg_hi:[1,0,0]
    v_pk_fma_f32 v[56:57], v[56:57], v[126:127], v[36:37] op_sel:[0,0,0] op_sel_hi:[1,0,1]
    v_pk_fma_f32 v[58:59], v[58:59], v[126:127], v[38:39] op_sel:[0,0,0] op_sel_hi:[1,0,1]
    v_pk_fma_f32 v[36:37], v[56:57], s[64:65], s[64:65] op_sel:[0,0,1] op_sel_hi:[1,0,1]
    v_pk_fma_f32 v[38:39], v[58:59], s[64:65], s[64:65] op_sel:[0,0,1] op_sel_hi:[1,0,1]
    v_exp_f32_e64 v36, v36 clamp
    v_exp_f32_e64 v37, v37 clamp
    v_exp_f32_e64 v38, v38 clamp
    v_exp_f32_e64 v39, v39 clamp
    v_max_f32 v56, s66, v56
    v_max_f32 v57, s66, v57
    v_max_f32 v58, s66, v58
    v_max_f32 v59, s66, v59
    v_pk_add_f32 v[56:57], v[56:57], v[36:37] op_sel:[0,0] op_sel_hi:[1,1]
    v_pk_add_f32 v[58:59], v[58:59], v[38:39] op_sel:[0,0] op_sel_hi:[1,1]
    v_cvt_pk_bf16_f32 v56, v56, v57
    v_cvt_pk_bf16_f32 v57, v58, v59
    buffer_store_dwordx2 v[56:57], v69, s[36:39], s53 offen sc1
    s_waitcnt vmcnt(2)
    s_barrier
    s_cmp_lg_u32 s48, 0
    s_cbranch_scc1 L_arr5
    v_mov_b32 v50, 1
    s_mov_b32 exec_hi, 0
    buffer_atomic_add v50, v32, s[36:39], 0 offen
    s_mov_b64 exec, -1
L_arr5:
    s_nop 0
    v_pk_fma_f32 v[36:37], v[128:129], v[42:43], s[66:67] op_sel:[1,0,0] op_sel_hi:[1,1,0] neg_lo:[1,0,0] neg_hi:[1,0,0]
    v_pk_fma_f32 v[38:39], v[128:129], v[44:45], s[66:67] op_sel:[1,0,0] op_sel_hi:[1,1,0] neg_lo:[1,0,0] neg_hi:[1,0,0]
    v_pk_fma_f32 v[60:61], v[60:61], v[128:129], v[36:37] op_sel:[0,0,0] op_sel_hi:[1,0,1]
    v_pk_fma_f32 v[62:63], v[62:63], v[128:129], v[38:39] op_sel:[0,0,0] op_sel_hi:[1,0,1]
    v_pk_fma_f32 v[36:37], v[60:61], s[64:65], s[64:65] op_sel:[0,0,1] op_sel_hi:[1,0,1]
    v_pk_fma_f32 v[38:39], v[62:63], s[64:65], s[64:65] op_sel:[0,0,1] op_sel_hi:[1,0,1]
    v_exp_f32_e64 v36, v36 clamp
    v_exp_f32_e64 v37, v37 clamp
    v_exp_f32_e64 v38, v38 clamp
    v_exp_f32_e64 v39, v39 clamp
    v_max_f32 v60, s66, v60
    v_max_f32 v61, s66, v61
    v_max_f32 v62, s66, v62
    v_max_f32 v63, s66, v63
    v_pk_add_f32 v[60:61], v[60:61], v[36:37] op_sel:[0,0] op_sel_hi:[1,1]
    v_pk_add_f32 v[62:63], v[62:63], v[38:39] op_sel:[0,0] op_sel_hi:[1,1]
    v_cvt_pk_bf16_f32 v60, v60, v61
    v_cvt_pk_bf16_f32 v61, v62, v63
    buffer_store_dwordx2 v[60:61], v70, s[36:39], s53 offen sc1
    v_pk_fma_f32 v[36:37], v[130:131], v[42:43], s[66:67] op_sel:[1,0,0] op_sel_hi:[1,1,0] neg_lo:[1,0,0] neg_hi:[1,0,0]
    v_pk_fma_f32 v[38:39], v[130:131], v[44:45], s[66:67] op_sel:[1,0,0] op_sel_hi:[1,1,0] neg_lo:[1,0,0] neg_hi:[1,0,0]
    v_pk_fma_f32 v[64:65], v[64:65], v[130:131], v[36:37] op_sel:[0,0,0] op_sel_hi:[1,0,1]
    v_pk_fma_f32 v[66:67], v[66:67], v[130:131], v[38:39] op_sel:[0,0,0] op_sel_hi:[1,0,1]
    v_pk_fma_f32 v[36:37], v[64:65], s[64:65], s[64:65] op_sel:[0,0,1] op_sel_hi:[1,0,1]
    v_pk_fma_f32 v[38:39], v[66:67], s[64:65], s[64:65] op_sel:[0,0,1] op_sel_hi:[1,0,1]
    v_exp_f32_e64 v36, v36 clamp
    v_exp_f32_e64 v37, v37 clamp
    v_exp_f32_e64 v38, v38 clamp
    v_exp_f32_e64 v39, v39 clamp
    v_max_f32 v64, s66, v64
    v_max_f32 v65, s66, v65
    v_max_f32 v66, s66, v66
    v_max_f32 v67, s66, v67
    v_pk_add_f32 v[64:65], v[64:65], v[36:37] op_sel:[0,0] op_sel_hi:[1,1]
    v_pk_add_f32 v[66:67], v[66:67], v[38:39] op_sel:[0,0] op_sel_hi:[1,1]
    v_cvt_pk_bf16_f32 v64, v64, v65
    v_cvt_pk_bf16_f32 v65, v66, v67
    buffer_store_dwordx2 v[64:65], v71, s[36:39], s53 offen sc1
    s_cmp_lg_u32 s48, 0
    s_cbranch_scc1 L_ps6
    s_mov_b64 exec, 0xff
    v_mov_b32_e64 v34, 0
    buffer_atomic_add v34, v33, s[36:39], 0 offen sc0
    s_mov_b64 exec, -1
L_ps6:
    ds_read_b64_tr_b16 v[50:51], v28 offset:0
    ds_read_b64_tr_b16 v[52:53], v29 offset:512
    ds_read_b64_tr_b16 v[54:55], v28 offset:1024
    ds_read_b64_tr_b16 v[56:57], v29 offset:1536
    s_nop 0
    s_mov_b32 s54, 0x1c000
    s_mov_b32 s55, 0xc00000
    s_mov_b32 s68, 0x1d000
    s_mov_b32 s69, 0xc01000
    v_xor_b32 v36, 8192, v27
    v_xor_b32 v37, 16384, v27
    v_xor_b32 v38, 24576, v27
    s_waitcnt lgkmcnt(3)
    v_lshlrev_b32 v58, 16, v50
    v_and_b32 v59, 0xffff0000, v50
    v_lshlrev_b32_e64 v60, 16, v51
    v_and_b32 v61, 0xffff0000, v51
    s_waitcnt lgkmcnt(2)
    v_lshlrev_b32 v62, 16, v52
    v_and_b32 v63, 0xffff0000, v52
    v_lshlrev_b32_e64 v64, 16, v53
    v_and_b32 v65, 0xffff0000, v53
    s_waitcnt lgkmcnt(1)
    v_lshlrev_b32 v66, 16, v54
    v_and_b32 v67, 0xffff0000, v54
    v_lshlrev_b32_e64 v68, 16, v55
    v_and_b32 v69, 0xffff0000, v55
    s_waitcnt lgkmcnt(0)
    v_lshlrev_b32 v70, 16, v56
    v_and_b32 v71, 0xffff0000, v56
    v_lshlrev_b32_e64 v72, 16, v57
    v_and_b32 v73, 0xffff0000, v57
    s_mov_b32 s67, s48
    s_branch L_pg7
.p2align 12
L_pg7:
    s_cmp_lg_u32 s48, 0
    s_cbranch_scc0 L_wait6_w0
    s_branch L_wait6
L_wait6_w0:
    s_mov_b64 exec, 0xff
    s_movk_i32 s53, 192
    s_mov_b32 s61, 0x100000
L_wait6_poll:
    v_mov_b32_e64 v35, 0
    buffer_atomic_add v35, v33, s[36:39], 0 offen sc0
    s_waitcnt vmcnt(1)
    v_cmp_gt_u32 vcc, s53, v34
    s_cbranch_vccz L_wait6_done
    v_mov_b32 v34, 0
    buffer_atomic_add v34, v33, s[36:39], 0 offen sc0
    s_sub_u32 s61, s61, 1
    s_cbranch_scc1 L_wait6_done
    s_waitcnt vmcnt(1)
    v_cmp_gt_u32 vcc, s53, v35
    s_cbranch_vccnz L_wait6_poll
L_wait6_done:
    s_mov_b64 exec, -1
L_wait6:
    s_barrier
L_redoq1:
    buffer_load_dwordx4 v[54:57], v26, s[36:39], s54 offen sc1
    buffer_load_dwordx4 v[74:77], v25, s[36:39], s54 offen offset:0 sc1
    buffer_load_dwordx4 v[78:81], v25, s[36:39], s54 offen offset:1024 sc1
    s_barrier
    buffer_load_dwordx4 v[106:109], v24, s[36:39], s55 offen offset:0 sc1
    buffer_load_dwordx4 v[110:113], v24, s[36:39], s55 offen offset:1024 sc1
    s_barrier
    buffer_load_dwordx4 v[82:85], v25, s[36:39], s54 offen offset:2048 sc1
    buffer_load_dwordx4 v[86:89], v25, s[36:39], s54 offen offset:3072 sc1
    buffer_load_dwordx4 v[114:117], v24, s[36:39], s55 offen offset:2048 sc1
    buffer_load_dwordx4 v[118:121], v24, s[36:39], s55 offen offset:3072 sc1
    s_barrier
    buffer_load_dwordx4 v[90:93], v25, s[36:39], s68 offen offset:0 sc1
    buffer_load_dwordx4 v[94:97], v25, s[36:39], s68 offen offset:1024 sc1
    buffer_load_dwordx4 v[122:125], v24, s[36:39], s69 offen offset:0 sc1
    buffer_load_dwordx4 v[126:129], v24, s[36:39], s69 offen offset:1024 sc1
    s_waitcnt vmcnt(12)
    v_cvt_pk_bf16_f32 v50, v54, v55
    v_cvt_pk_bf16_f32 v51, v56, v57
    v_cvt_pk_bf16_f32 v52, v54, v55
    v_cvt_pk_bf16_f32 v53, v56, v57
    s_waitcnt vmcnt(11)
    v_cvt_pk_bf16_f32 v74, v74, v75
    v_cvt_pk_bf16_f32 v75, v76, v77
    s_waitcnt vmcnt(10)
    v_cvt_pk_bf16_f32 v76, v78, v79
    v_cvt_pk_bf16_f32 v77, v80, v81
    v_permlane16_swap_b32 v50, v52
    v_permlane16_swap_b32 v51, v53
    s_nop 0
    v_cndmask_b32 v78, v50, v74, s[58:59]
    v_cndmask_b32 v79, v51, v75, s[58:59]
    v_cndmask_b32 v80, v52, v76, s[58:59]
    v_cndmask_b32 v81, v53, v77, s[58:59]
    v_cndmask_b32 v74, v74, v50, s[58:59]
    v_cndmask_b32 v75, v75, v51, s[58:59]
    v_cndmask_b32 v76, v76, v52, s[58:59]
    v_cndmask_b32 v77, v77, v53, s[58:59]
    s_waitcnt vmcnt(9)
    s_nop 0
    v_mfma_f32_32x32x16_bf16 v[138:153], v[74:77], v[106:109], 0
    s_waitcnt vmcnt(8)
    v_mfma_f32_32x32x16_bf16 v[154:169], v[78:81], v[110:113], 0
    buffer_load_dwordx4 v[98:101], v25, s[36:39], s68 offen offset:2048 sc1
    buffer_load_dwordx4 v[102:105], v25, s[36:39], s68 offen offset:3072 sc1
    buffer_load_dwordx4 v[130:133], v24, s[36:39], s69 offen offset:2048 sc1
    buffer_load_dwordx4 v[134:137], v24, s[36:39], s69 offen offset:3072 sc1
    s_nop 5
    v_add_f32 v146, s66, v146
    v_rcp_f32 v146, v146
    v_add_f32 v155, s66, v155
    v_rcp_f32 v155, v155
    v_mul_f32 v138, v146, v138
    v_mul_f32 v139, v146, v139
    v_mul_f32 v140, v146, v140
    v_mul_f32 v141, v146, v141
    v_mul_f32 v142, v146, v142
    v_mul_f32 v143, v146, v143
    v_mul_f32 v144, v146, v144
    v_mul_f32 v145, v146, v145
    v_cvt_pk_bf16_f32 v106, v138, v139
    v_cvt_pk_bf16_f32 v107, v140, v141
    v_cvt_pk_bf16_f32 v108, v142, v143
    v_cvt_pk_bf16_f32 v109, v144, v145
    ds_write_b128 v27, v[106:109] offset:0
    v_mul_f32 v162, v155, v162
    v_mul_f32 v163, v155, v163
    v_mul_f32 v164, v155, v164
    v_mul_f32 v165, v155, v165
    v_mul_f32 v166, v155, v166
    v_mul_f32 v167, v155, v167
    v_mul_f32 v168, v155, v168
    v_mul_f32 v169, v155, v169
    v_cvt_pk_bf16_f32 v110, v162, v163
    v_cvt_pk_bf16_f32 v111, v164, v165
    v_cvt_pk_bf16_f32 v112, v166, v167
    v_cvt_pk_bf16_f32 v113, v168, v169
    ds_write_b128 v27, v[110:113] offset:1024
    s_waitcnt vmcnt(11)
    v_cvt_pk_bf16_f32 v82, v82, v83
    v_cvt_pk_bf16_f32 v83, v84, v85
    s_waitcnt vmcnt(10)
    v_cvt_pk_bf16_f32 v84, v86, v87
    v_cvt_pk_bf16_f32 v85, v88, v89
    v_cndmask_b32 v86, v50, v82, s[58:59]
    v_cndmask_b32 v87, v51, v83, s[58:59]
    v_cndmask_b32 v88, v52, v84, s[58:59]
    v_cndmask_b32 v89, v53, v85, s[58:59]
    v_cndmask_b32 v82, v82, v50, s[58:59]
    v_cndmask_b32 v83, v83, v51, s[58:59]
    v_cndmask_b32 v84, v84, v52, s[58:59]
    v_cndmask_b32 v85, v85, v53, s[58:59]
    s_waitcnt lgkmcnt(0)
    s_barrier
    s_cmp_lg_u32 s67, 1
    s_cbranch_scc1 L_nofbq1
    s_mov_b32 s53, 0x2c000
    v_mov_b32 v34, 1
    s_mov_b64 exec, 1
    buffer_atomic_add v34, v32, s[36:39], s53 offen
    s_mov_b64 exec, -1
L_nofbq1:
    s_waitcnt vmcnt(9)
    v_mfma_f32_32x32x16_bf16 v[138:153], v[82:85], v[114:117], 0
    ds_read_b128 v[54:57], v36 offset:0
    ds_read_b128 v[170:173], v36 offset:1024
    ds_read_b128 v[174:177], v37 offset:0
    s_waitcnt vmcnt(8)
    v_mfma_f32_32x32x16_bf16 v[154:169], v[86:89], v[118:121], 0
    ds_read_b128 v[178:181], v37 offset:1024
    ds_read_b128 v[182:185], v38 offset:0
    ds_read_b128 v[186:189], v38 offset:1024
    v_mfma_f32_32x32x16_bf16 v[58:73], a[192:195], v[106:109], v[58:73]
    s_nop 2
    v_add_f32_e64 v148, s66, v148
    v_mfma_f32_32x32x16_bf16 v[58:73], a[196:199], v[110:113], v[58:73]
    v_rcp_f32 v148, v148
    s_nop 1
    v_add_f32 v157, s66, v157
    v_rcp_f32 v157, v157
    v_mul_f32 v138, v148, v138
    v_mul_f32 v139, v148, v139
    s_waitcnt lgkmcnt(3)
    v_mfma_f32_32x32x16_bf16 v[58:73], a[224:227], v[54:57], v[58:73]
    v_mul_f32 v140, v148, v140
    v_mul_f32 v141, v148, v141
    v_mul_f32 v142, v148, v142
    v_mul_f32 v143, v148, v143
    v_mul_f32 v144, v148, v144
    v_mfma_f32_32x32x16_bf16 v[58:73], a[228:231], v[170:173], v[58:73]
    v_mul_f32_e64 v145, v148, v145
    v_cvt_pk_bf16_f32 v114, v138, v139
    v_cvt_pk_bf16_f32 v115, v140, v141
    v_cvt_pk_bf16_f32 v116, v142, v143
    v_cvt_pk_bf16_f32 v117, v144, v145
    v_mfma_f32_32x32x16_bf16 v[58:73], v[192:195], v[174:177], v[58:73]
    ds_write_b128 v27, v[114:117] offset:2048
    v_mul_f32 v162, v157, v162
    v_mul_f32 v163, v157, v163
    v_mul_f32 v164, v157, v164
    v_mul_f32 v165, v157, v165
    v_mul_f32 v166, v157, v166
    s_waitcnt lgkmcnt(1)
    v_mfma_f32_32x32x16_bf16 v[58:73], v[196:199], v[178:181], v[58:73]
    v_mul_f32 v167, v157, v167
    v_mul_f32 v168, v157, v168
    v_mul_f32_e64 v169, v157, v169
    v_cvt_pk_bf16_f32 v118, v162, v163
    v_cvt_pk_bf16_f32 v119, v164, v165
    v_cvt_pk_bf16_f32 v120, v166, v167
    v_cvt_pk_bf16_f32 v121, v168, v169
    v_mfma_f32_32x32x16_bf16 v[58:73], v[224:227], v[182:185], v[58:73]
    ds_write_b128 v27, v[118:121] offset:3072
    s_waitcnt vmcnt(7)
    v_cvt_pk_bf16_f32 v90, v90, v91
    v_cvt_pk_bf16_f32 v91, v92, v93
    s_waitcnt vmcnt(6)
    v_cvt_pk_bf16_f32 v92, v94, v95
    v_cvt_pk_bf16_f32 v93, v96, v97
    v_mfma_f32_32x32x16_bf16 v[58:73], v[228:231], v[186:189], v[58:73]
    v_cndmask_b32 v94, v50, v90, s[58:59]
    v_cndmask_b32 v95, v51, v91, s[58:59]
    v_cndmask_b32 v96, v52, v92, s[58:59]
    v_cndmask_b32 v97, v53, v93, s[58:59]
    v_cndmask_b32 v90, v90, v50, s[58:59]
    v_cndmask_b32 v91, v91, v51, s[58:59]
    v_cndmask_b32 v92, v92, v52, s[58:59]
    v_cndmask_b32 v93, v93, v53, s[58:59]
    s_waitcnt lgkmcnt(0)
    s_barrier
    s_waitcnt vmcnt(5)
    v_mfma_f32_32x32x16_bf16 v[138:153], v[90:93], v[122:125], 0
    ds_read_b128 v[54:57], v36 offset:2048
    ds_read_b128 v[170:173], v36 offset:3072
    ds_read_b128 v[174:177], v37 offset:2048
    s_waitcnt vmcnt(4)
    v_mfma_f32_32x32x16_bf16 v[154:169], v[94:97], v[126:129], 0
    ds_read_b128 v[178:181], v37 offset:3072
    ds_read_b128 v[182:185], v38 offset:2048
    ds_read_b128 v[186:189], v38 offset:3072
    v_mfma_f32_32x32x16_bf16 v[58:73], a[200:203], v[114:117], v[58:73]
    s_nop 2
    v_add_f32 v150, s66, v150
    v_mfma_f32_32x32x16_bf16 v[58:73], a[204:207], v[118:121], v[58:73]
    v_rcp_f32 v150, v150
    s_nop 1
    v_add_f32 v159, s66, v159
    v_rcp_f32 v159, v159
    v_mul_f32 v138, v150, v138
    v_mul_f32 v139, v150, v139
    s_waitcnt lgkmcnt(3)
    v_mfma_f32_32x32x16_bf16 v[58:73], a[232:235], v[54:57], v[58:73]
    v_mul_f32 v140, v150, v140
    v_mul_f32 v141, v150, v141
    v_mul_f32 v142, v150, v142
    v_mul_f32 v143, v150, v143
    v_mul_f32 v144, v150, v144
    v_mfma_f32_32x32x16_bf16 v[58:73], a[236:239], v[170:173], v[58:73]
    v_mul_f32_e64 v145, v150, v145
    v_cvt_pk_bf16_f32 v122, v138, v139
    v_cvt_pk_bf16_f32 v123, v140, v141
    v_cvt_pk_bf16_f32 v124, v142, v143
    v_cvt_pk_bf16_f32 v125, v144, v145
    v_mfma_f32_32x32x16_bf16 v[58:73], v[200:203], v[174:177], v[58:73]
    ds_write_b128 v27, v[122:125] offset:4096
    v_mul_f32 v162, v159, v162
    v_mul_f32 v163, v159, v163
    v_mul_f32 v164, v159, v164
    v_mul_f32 v165, v159, v165
    v_mul_f32 v166, v159, v166
    s_waitcnt lgkmcnt(1)
    v_mfma_f32_32x32x16_bf16 v[58:73], v[204:207], v[178:181], v[58:73]
    v_mul_f32 v167, v159, v167
    v_mul_f32 v168, v159, v168
    v_mul_f32_e64 v169, v159, v169
    v_cvt_pk_bf16_f32 v126, v162, v163
    v_cvt_pk_bf16_f32 v127, v164, v165
    v_cvt_pk_bf16_f32 v128, v166, v167
    v_cvt_pk_bf16_f32 v129, v168, v169
    v_mfma_f32_32x32x16_bf16 v[58:73], v[232:235], v[182:185], v[58:73]
    ds_write_b128 v27, v[126:129] offset:5120
    s_waitcnt vmcnt(3)
    v_cvt_pk_bf16_f32 v98, v98, v99
    v_cvt_pk_bf16_f32 v99, v100, v101
    s_waitcnt vmcnt(2)
    v_cvt_pk_bf16_f32 v100, v102, v103
    v_cvt_pk_bf16_f32 v101, v104, v105
    v_mfma_f32_32x32x16_bf16 v[58:73], v[236:239], v[186:189], v[58:73]
    v_cndmask_b32 v102, v50, v98, s[58:59]
    v_cndmask_b32 v103, v51, v99, s[58:59]
    v_cndmask_b32 v104, v52, v100, s[58:59]
    v_cndmask_b32 v105, v53, v101, s[58:59]
    v_cndmask_b32 v98, v98, v50, s[58:59]
    v_cndmask_b32 v99, v99, v51, s[58:59]
    v_cndmask_b32 v100, v100, v52, s[58:59]
    v_cndmask_b32 v101, v101, v53, s[58:59]
    s_waitcnt lgkmcnt(0)
    s_barrier
    s_waitcnt vmcnt(1)
    v_mfma_f32_32x32x16_bf16 v[138:153], v[98:101], v[130:133], 0
    ds_read_b128 v[54:57], v36 offset:4096
    ds_read_b128 v[170:173], v36 offset:5120
    ds_read_b128 v[174:177], v37 offset:4096
    s_waitcnt vmcnt(0)
    v_mfma_f32_32x32x16_bf16 v[154:169], v[102:105], v[134:137], 0
    ds_read_b128 v[178:181], v37 offset:5120
    ds_read_b128 v[182:185], v38 offset:4096
    ds_read_b128 v[186:189], v38 offset:5120
    v_mfma_f32_32x32x16_bf16 v[58:73], a[208:211], v[122:125], v[58:73]
    s_nop 2
    v_add_f32 v152, s66, v152
    v_mfma_f32_32x32x16_bf16 v[58:73], a[212:215], v[126:129], v[58:73]
    v_rcp_f32 v152, v152
    s_nop 1
    v_add_f32 v161, s66, v161
    v_rcp_f32 v161, v161
    v_mul_f32 v138, v152, v138
    v_mul_f32 v139, v152, v139
    v_mul_f32 v140, v152, v140
    s_waitcnt lgkmcnt(3)
    v_mfma_f32_32x32x16_bf16 v[58:73], a[240:243], v[54:57], v[58:73]
    v_mul_f32 v141, v152, v141
    v_mul_f32 v142, v152, v142
    v_mul_f32 v143, v152, v143
    v_mul_f32 v144, v152, v144
    v_mul_f32_e64 v145, v152, v145
    v_mfma_f32_32x32x16_bf16 v[58:73], a[244:247], v[170:173], v[58:73]
    v_cvt_pk_bf16_f32 v130, v138, v139
    v_cvt_pk_bf16_f32 v131, v140, v141
    v_cvt_pk_bf16_f32 v132, v142, v143
    v_cvt_pk_bf16_f32 v133, v144, v145
    v_mfma_f32_32x32x16_bf16 v[58:73], v[208:211], v[174:177], v[58:73]
    ds_write_b128 v27, v[130:133] offset:6144
    v_mul_f32 v162, v161, v162
    v_mul_f32 v163, v161, v163
    v_mul_f32 v164, v161, v164
    v_mul_f32 v165, v161, v165
    v_mul_f32 v166, v161, v166
    s_waitcnt lgkmcnt(1)
    v_mfma_f32_32x32x16_bf16 v[58:73], v[212:215], v[178:181], v[58:73]
    v_mul_f32 v167, v161, v167
    v_mul_f32 v168, v161, v168
    v_mul_f32_e64 v169, v161, v169
    v_cvt_pk_bf16_f32 v134, v162, v163
    v_cvt_pk_bf16_f32 v135, v164, v165
    v_cvt_pk_bf16_f32 v136, v166, v167
    v_cvt_pk_bf16_f32 v137, v168, v169
    v_mfma_f32_32x32x16_bf16 v[58:73], v[240:243], v[182:185], v[58:73]
    ds_write_b128 v27, v[134:137] offset:7168
    v_mfma_f32_32x32x16_bf16 v[58:73], v[244:247], v[186:189], v[58:73]
    s_waitcnt lgkmcnt(0)
    s_barrier
    ds_read_b128 v[54:57], v36 offset:6144
    ds_read_b128 v[170:173], v36 offset:7168
    v_mfma_f32_32x32x16_bf16 v[58:73], a[216:219], v[130:133], v[58:73]
    ds_read_b128 v[174:177], v37 offset:6144
    ds_read_b128 v[178:181], v37 offset:7168
    v_mfma_f32_32x32x16_bf16 v[58:73], a[220:223], v[134:137], v[58:73]
    ds_read_b128 v[182:185], v38 offset:6144
    ds_read_b128 v[186:189], v38 offset:7168
    s_waitcnt lgkmcnt(5)
    v_mfma_f32_32x32x16_bf16 v[58:73], a[248:251], v[54:57], v[58:73]
    s_waitcnt lgkmcnt(4)
    v_mfma_f32_32x32x16_bf16 v[58:73], a[252:255], v[170:173], v[58:73]
    s_waitcnt lgkmcnt(3)
    v_mfma_f32_32x32x16_bf16 v[58:73], v[216:219], v[174:177], v[58:73]
    s_waitcnt lgkmcnt(2)
    v_mfma_f32_32x32x16_bf16 v[58:73], v[220:223], v[178:181], v[58:73]
    s_waitcnt lgkmcnt(1)
    v_mfma_f32_32x32x16_bf16 v[58:73], v[248:251], v[182:185], v[58:73]
    s_waitcnt lgkmcnt(0)
    v_mfma_f32_32x32x16_bf16 v[58:73], v[252:255], v[186:189], v[58:73]
    s_mul_i32 s54, s48, 2560
    s_add_u32 s54, s54, 98304
    v_and_b32_e64 v36, 31, v1
    v_mul_u32_u24 v36, 80, v36
    v_and_b32_e64 v37, 32, v1
    v_add3_u32 v36, v36, v37, s54
    v_readfirstlane_b32 s53, v7
    v_lshrrev_b32 v37, 2, v1
    v_lshl_add_u32 v38, v37, 4, v2
    v_add_u32_e64 v38, s54, v38
    v_mul_u32_u24 v37, 960, v37
    v_add3_u32 v37, v37, v2, s53
    v_cmp_u_f32 vcc, v58, v58
    s_cbranch_vccnz L_slowq1
L_okq1:
    v_cvt_pk_bf16_f32 v50, v58, v59
    v_cvt_pk_bf16_f32 v51, v60, v61
    v_cvt_pk_bf16_f32 v52, v62, v63
    v_cvt_pk_bf16_f32 v53, v64, v65
    v_cvt_pk_bf16_f32 v54, v66, v67
    v_cvt_pk_bf16_f32 v55, v68, v69
    v_cvt_pk_bf16_f32 v56, v70, v71
    v_cvt_pk_bf16_f32 v57, v72, v73
    ds_write_b128 v36, v[50:53] offset:0
    ds_write_b128 v36, v[54:57] offset:16
    v_add_u32 v36, 16384, v37
    ds_read_b128 v[50:53], v38 offset:0
    ds_read_b128 v[54:57], v38 offset:1280
    s_waitcnt lgkmcnt(1)
    global_store_dwordx4 v37, v[50:53], s[28:29] sc1
    s_waitcnt lgkmcnt(0)
    global_store_dwordx4 v36, v[54:57], s[28:29] sc1
L_end:
    s_endpgm
L_slowx0:
    s_cmp_ge_u32 s67, 12
    s_cbranch_scc1 L_okx0
    s_add_u32 s67, s67, 4
    s_waitcnt vmcnt(0) lgkmcnt(0)
    s_cmp_lg_u32 s48, 0
    s_cbranch_scc1 L_slowbx0
    s_mov_b32 s61, 0x100000
    s_mov_b32 s53, 0x2c000
    s_movk_i32 s54, 32
    s_mov_b64 exec, 0xff
    v_lshlrev_b32 v35, 7, v1
L_slowpx0:
    v_mov_b32 v34, 0
    buffer_atomic_add v34, v35, s[36:39], s53 offen sc0
    s_sub_u32 s61, s61, 1
    s_cbranch_scc1 L_slowdx0
    s_waitcnt vmcnt(0)
    v_cmp_gt_u32 vcc, s54, v34
    s_cbranch_vccnz L_slowpx0
L_slowdx0:
    s_mov_b64 exec, -1
    s_waitcnt vmcnt(0)
L_slowbx0:
    s_nop 15
    s_waitcnt lgkmcnt(0)
    s_barrier
    s_branch L_redox0
L_slowq0:
    s_cmp_ge_u32 s67, 12
    s_cbranch_scc1 L_okq0
    s_add_u32 s67, s67, 4
    s_waitcnt vmcnt(0) lgkmcnt(0)
    s_cmp_lg_u32 s48, 0
    s_cbranch_scc1 L_slowbq0
    s_mov_b32 s61, 0x100000
    s_mov_b32 s53, 0x2c000
    s_movk_i32 s54, 64
    s_mov_b64 exec, 0xff
    v_lshlrev_b32 v35, 7, v1
L_slowpq0:
    v_mov_b32 v34, 0
    buffer_atomic_add v34, v35, s[36:39], s53 offen sc0
    s_sub_u32 s61, s61, 1
    s_cbranch_scc1 L_slowdq0
    s_waitcnt vmcnt(0)
    v_cmp_gt_u32 vcc, s54, v34
    s_cbranch_vccnz L_slowpq0
L_slowdq0:
    s_mov_b64 exec, -1
    s_waitcnt vmcnt(0)
L_slowbq0:
    s_nop 15
    ds_read_b64_tr_b16 v[50:51], v28 offset:0
    ds_read_b64_tr_b16 v[52:53], v29 offset:512
    ds_read_b64_tr_b16 v[54:55], v28 offset:1024
    ds_read_b64_tr_b16 v[56:57], v29 offset:1536
    s_mov_b32 s54, 0x10000
    s_mov_b32 s55, 0xa00000
    s_mov_b32 s68, 0x11000
    s_mov_b32 s69, 0xa01000
    v_xor_b32 v36, 8192, v27
    v_xor_b32 v37, 16384, v27
    v_xor_b32 v38, 24576, v27
    s_waitcnt lgkmcnt(3)
    v_lshlrev_b32 v58, 16, v50
    v_and_b32 v59, 0xffff0000, v50
    v_lshlrev_b32_e64 v60, 16, v51
    v_and_b32 v61, 0xffff0000, v51
    s_waitcnt lgkmcnt(2)
    v_lshlrev_b32 v62, 16, v52
    v_and_b32 v63, 0xffff0000, v52
    v_lshlrev_b32_e64 v64, 16, v53
    v_and_b32 v65, 0xffff0000, v53
    s_waitcnt lgkmcnt(1)
    v_lshlrev_b32 v66, 16, v54
    v_and_b32 v67, 0xffff0000, v54
    v_lshlrev_b32_e64 v68, 16, v55
    v_and_b32 v69, 0xffff0000, v55
    s_waitcnt lgkmcnt(0)
    v_lshlrev_b32 v70, 16, v56
    v_and_b32 v71, 0xffff0000, v56
    v_lshlrev_b32_e64 v72, 16, v57
    v_and_b32 v73, 0xffff0000, v57
    s_waitcnt lgkmcnt(0)
    s_barrier
    s_branch L_redoq0
L_slowc1:
    s_cmp_ge_u32 s67, 12
    s_cbranch_scc1 L_okc1
    s_add_u32 s67, s67, 4
    s_waitcnt vmcnt(0) lgkmcnt(0)
    s_cmp_lt_u32 s67, 8
    s_cbranch_scc1 L_slowdc1
    s_mov_b32 s61, 0x100000
    s_mov_b32 s53, 0x2c000
    s_movk_i32 s54, 96
    s_mov_b64 exec, 0xff
    v_lshlrev_b32 v35, 7, v1
L_slowpc1:
    v_mov_b32 v34, 0
    buffer_atomic_add v34, v35, s[36:39], s53 offen sc0
    s_sub_u32 s61, s61, 1
    s_cbranch_scc1 L_slowdc1
    s_waitcnt vmcnt(0)
    v_cmp_gt_u32 vcc, s54, v34
    s_cbranch_vccnz L_slowpc1
L_slowdc1:
    s_mov_b64 exec, -1
    s_waitcnt vmcnt(0)
L_slowbc1:
    s_nop 15
    buffer_load_dwordx4 v[74:77], v10, s[36:39], s10 offen offset:0 sc1
    buffer_load_dwordx4 v[78:81], v10, s[36:39], s11 offen offset:0 sc1
    buffer_load_dwordx4 v[82:85], v10, s[36:39], s12 offen offset:0 sc1
    buffer_load_dwordx4 v[86:89], v10, s[36:39], s13 offen offset:0 sc1
    buffer_load_dwordx4 v[50:53], v10, s[36:39], s68 offen offset:0 sc1
    buffer_load_dwordx4 v[90:93], v10, s[36:39], s10 offen offset:1024 sc1
    buffer_load_dwordx4 v[94:97], v10, s[36:39], s11 offen offset:1024 sc1
    buffer_load_dwordx4 v[98:101], v10, s[36:39], s12 offen offset:1024 sc1
    buffer_load_dwordx4 v[102:105], v10, s[36:39], s13 offen offset:1024 sc1
    buffer_load_dwordx4 v[54:57], v10, s[36:39], s68 offen offset:1024 sc1
    s_waitcnt vmcnt(0)
    s_branch L_redoc1
L_slowx1:
    s_cmp_ge_u32 s67, 12
    s_cbranch_scc1 L_okx1
    s_add_u32 s67, s67, 4
    s_waitcnt vmcnt(0) lgkmcnt(0)
    s_cmp_lg_u32 s48, 0
    s_cbranch_scc1 L_slowbx1
    s_mov_b32 s61, 0x100000
    s_mov_b32 s53, 0x2c000
    s_movk_i32 s54, 128
    s_mov_b64 exec, 0xff
    v_lshlrev_b32 v35, 7, v1
L_slowpx1:
    v_mov_b32_e64 v34, 0
    buffer_atomic_add v34, v35, s[36:39], s53 offen sc0
    s_sub_u32 s61, s61, 1
    s_cbranch_scc1 L_slowdx1
    s_waitcnt vmcnt(0)
    v_cmp_gt_u32 vcc, s54, v34
    s_cbranch_vccnz L_slowpx1
L_slowdx1:
    s_mov_b64 exec, -1
    s_waitcnt vmcnt(0)
L_slowbx1:
    s_nop 15
    s_waitcnt lgkmcnt(0)
    s_barrier
    s_branch L_redox1
L_slowq1:
    s_cmp_ge_u32 s67, 12
    s_cbranch_scc1 L_okq1
    s_add_u32 s67, s67, 4
    s_waitcnt vmcnt(0) lgkmcnt(0)
    s_cmp_lg_u32 s48, 0
    s_cbranch_scc1 L_slowbq1
    s_mov_b32 s61, 0x100000
    s_mov_b32 s53, 0x2c000
    s_movk_i32 s54, 160
    s_mov_b64 exec, 0xff
    v_lshlrev_b32 v35, 7, v1
L_slowpq1:
    v_mov_b32 v34, 0
    buffer_atomic_add v34, v35, s[36:39], s53 offen sc0
    s_sub_u32 s61, s61, 1
    s_cbranch_scc1 L_slowdq1
    s_waitcnt vmcnt(0)
    v_cmp_gt_u32 vcc, s54, v34
    s_cbranch_vccnz L_slowpq1
L_slowdq1:
    s_mov_b64 exec, -1
    s_waitcnt vmcnt(0)
L_slowbq1:
    s_nop 15
    ds_read_b64_tr_b16 v[50:51], v28 offset:0
    ds_read_b64_tr_b16 v[52:53], v29 offset:512
    ds_read_b64_tr_b16 v[54:55], v28 offset:1024
    ds_read_b64_tr_b16 v[56:57], v29 offset:1536
    s_mov_b32 s54, 0x1c000
    s_mov_b32 s55, 0xc00000
    s_mov_b32 s68, 0x1d000
    s_mov_b32 s69, 0xc01000
    v_xor_b32 v36, 8192, v27
    v_xor_b32 v37, 16384, v27
    v_xor_b32 v38, 24576, v27
    s_waitcnt lgkmcnt(3)
    v_lshlrev_b32 v58, 16, v50
    v_and_b32 v59, 0xffff0000, v50
    v_lshlrev_b32_e64 v60, 16, v51
    v_and_b32 v61, 0xffff0000, v51
    s_waitcnt lgkmcnt(2)
    v_lshlrev_b32 v62, 16, v52
    v_and_b32 v63, 0xffff0000, v52
    v_lshlrev_b32_e64 v64, 16, v53
    v_and_b32 v65, 0xffff0000, v53
    s_waitcnt lgkmcnt(1)
    v_lshlrev_b32 v66, 16, v54
    v_and_b32 v67, 0xffff0000, v54
    v_lshlrev_b32_e64 v68, 16, v55
    v_and_b32 v69, 0xffff0000, v55
    s_waitcnt lgkmcnt(0)
    v_lshlrev_b32 v70, 16, v56
    v_and_b32 v71, 0xffff0000, v56
    v_lshlrev_b32_e64 v72, 16, v57
    v_and_b32 v73, 0xffff0000, v57
    s_waitcnt lgkmcnt(0)
    s_barrier
    s_branch L_redoq1
.section .rodata,"a"
.p2align 6
.amdhsa_kernel interleave_layers__ssm_conv_s4__linear_attn_block__prompt_kernel
  .amdhsa_next_free_vgpr 512
  .amdhsa_next_free_sgpr 102
  .amdhsa_accum_offset 256
  .amdhsa_group_segment_fixed_size 0
  .amdhsa_kernarg_size 120
  .amdhsa_user_sgpr_count 2
  .amdhsa_user_sgpr_kernarg_segment_ptr 1
  .amdhsa_system_sgpr_workgroup_id_x 1
.end_amdhsa_kernel
```
